```python
import torch

def _softmax(x, axis=-1):
    return torch.softmax(x, dim=axis)

def _gelu(x):
    return torch.nn.functional.gelu(x, approximate='tanh')

def _silu(x):
    return torch.nn.functional.silu(x)

def _sigmoid(x):
    return torch.sigmoid(x)

def _layernorm(x, axis=-1, eps=1e-05):
    m = x.mean(dim=axis, keepdim=True)
    v = x.var(dim=axis, keepdim=True, unbiased=False)
    return (x - m) / torch.sqrt(v + eps)

def _scatter_add(tgt, idx, src, axis=0):
    return tgt.clone().index_add_(axis, idx, src)

def _segment_sum(src, seg, n):
    out = torch.zeros((n,) + src.shape[1:], dtype=src.dtype)
    return out.index_add_(0, seg, src)

def _pad(x, pw):
    flat = tuple((v for pair in reversed(pw) for v in pair))
    return torch.nn.functional.pad(x, flat)
kernel_name = 'adaLN_cond__sliding_block_cached__swiglu_ffn__decode'

def setup_inputs():

    _w = lambda a: (lambda t: t.to(torch.bfloat16) if t.is_floating_point() else t)(torch.as_tensor(a))

    def _A_setup():
        B, Sq, D = (2, 1, 512)
        Hq, Hkv, Sk, Dh = (32, 8, 32768, 128)
        assert Hq % Hkv == 0, (Hq, Hkv)
        return {'x': _w((lambda *s: torch.randn(*s, dtype=torch.bfloat16) * 0.05)(B, Sq, D)), 'k_cache': _w((lambda *s: torch.randn(*s, dtype=torch.bfloat16) * 3.2)(B, Hkv, Sk, Dh)), 'v_cache': _w((lambda *s: torch.randn(*s, dtype=torch.bfloat16) * 0.4)(B, Hkv, Sk, Dh)), 'wq': _w((lambda *s: torch.randn(*s, dtype=torch.bfloat16) * 3.2)(D, Hq * Dh) * D ** (-0.5)), 'wo': _w((lambda *s: torch.randn(*s, dtype=torch.bfloat16) * 0.4)(Hq * Dh, D) * (Hq * Dh) ** (-0.5))}
    _A_in = _A_setup()

    def _B_setup():
        B, S, D, F = (2, 1, 512, 1792)
        return {'x': _w((lambda *s: torch.randn(*s, dtype=torch.bfloat16) * 0.05)(B, S, D)), 'w_gate': _w((lambda *s: torch.randn(*s, dtype=torch.bfloat16) * 0.05)(D, F)), 'w_up': _w((lambda *s: torch.randn(*s, dtype=torch.bfloat16) * 0.05)(D, F)), 'w_down': _w((lambda *s: torch.randn(*s, dtype=torch.bfloat16) * 0.05)(F, D))}
    _B_in = _B_setup()
    return {'A_x': _A_in['x'], 'A_k_cache': _A_in['k_cache'], 'A_v_cache': _A_in['v_cache'], 'A_wq': _A_in['wq'], 'A_wo': _A_in['wo'], 'B_x': _B_in['x'], 'B_w_gate': _B_in['w_gate'], 'B_w_up': _B_in['w_up'], 'B_w_down': _B_in['w_down'], 'c': _w((lambda *s: torch.randn(*s, dtype=torch.bfloat16) * 0.2)(2, 512) * 8.0), 'w_mod': _w((lambda *s: torch.randn(*s, dtype=torch.bfloat16) * 0.2)(512, 6 * 512) * 512 ** (-0.5) * 8.0)}

def reference(A_x, A_k_cache, A_v_cache, A_wq, A_wo, B_x, B_w_gate, B_w_up, B_w_down, c, w_mod):

    def _A_ref(x, k_cache, v_cache, wq, wo):
        B, Sq, D = x.shape
        Hq, Dh = (32, 128)
        Hkv, Sk = (k_cache.shape[1], k_cache.shape[2])
        W = min(4096, max(256, Sk // 4))
        rep = Hq // Hkv
        q = (lambda x, *d: x.permute(*d))((x @ wq).reshape(B, Sq, Hq, Dh), 0, 2, 1, 3)
        k = (lambda x, n, axis: torch.repeat_interleave(x, n, dim=axis))(k_cache[:, :, Sk - W:, :], rep, axis=1)
        v = (lambda x, n, axis: torch.repeat_interleave(x, n, dim=axis))(v_cache[:, :, Sk - W:, :], rep, axis=1)
        scores = torch.einsum('bhqd,bhkd->bhqk', q, k) * Dh ** (-0.5)
        p = _softmax(scores, axis=-1)
        o = torch.einsum('bhqk,bhkd->bhqd', p, v)
        return (lambda x, *d: x.permute(*d))(o, 0, 2, 1, 3).reshape(B, Sq, Hq * Dh) @ wo

    def _B_ref(x, w_gate, w_up, w_down):
        g = _silu(x @ w_gate)
        u = x @ w_up
        return g * u @ w_down
    x = A_x
    mod = (_silu(c) @ w_mod).reshape(c.shape[0], 6, 1, -1)
    sa, ca, ga, sb, cb, gb = (mod[:, 0].clone(), mod[:, 1].clone(), mod[:, 2].clone(), mod[:, 3].clone(), mod[:, 4].clone(), mod[:, 5].clone())
    h = _layernorm(x, axis=-1) * (1 + ca) + sa
    x = x + ga * _A_ref(h, A_k_cache, A_v_cache, A_wq, A_wo)
    h = _layernorm(x, axis=-1) * (1 + cb) + sb
    x = x + gb * _B_ref(h, B_w_gate, B_w_up, B_w_down)
    return x
```

```asm
; @launch grid=(256,1,1) block=(768,1,1) lds=120832
.amdgcn_target "amdgcn-amd-amdhsa--gfx950"
.text
.globl adaLN_cond__sliding_block_cached__swiglu_ffn__decode_kernel
.p2align 12
.p2align 8
.type adaLN_cond__sliding_block_cached__swiglu_ffn__decode_kernel,@function
adaLN_cond__sliding_block_cached__swiglu_ffn__decode_kernel:
    s_cmp_ge_u32 s2, 256
    s_cbranch_scc1 L_exit
    s_load_dwordx16 s[36:51], s[0:1], 0
    s_load_dwordx8 s[52:59], s[0:1], 64
    s_load_dwordx4 s[60:63], s[0:1], 96
    v_lshrrev_b32 v1, 6, v0
    v_and_b32 v0, 63, v0
    v_readfirstlane_b32 s3, v1
    v_lshrrev_b32 v1, 4, v0
    v_and_b32 v2, 15, v0
    v_lshlrev_b32 v3, 4, v0
    s_and_b32 s4, s2, 7
    s_lshr_b32 s5, s2, 3
    s_mov_b32 s69, 0xffffff00
    s_mov_b32 s70, 0xffff0000
    s_cmp_lg_u32 s3, 2
    s_cbranch_scc1 L_nopf
    s_getpc_b64 s[28:29]
L_pc:
    s_min_u32 s30, s5, (L_exit-L_pc)/1024-1
    s_lshl_b32 s30, s30, 10
    s_add_u32 s30, s30, (L_exit-L_pc)&0x3f0
    v_add_u32 v12, s30, v3
    global_load_dwordx4 v[160:163], v12, s[28:29]
L_nopf:
    s_cmp_lt_u32 s5, 8
    s_cbranch_scc1 L_W
    s_and_b32 s6, s5, 1
    s_sub_u32 s7, s5, 8
    s_lshr_b32 s7, s7, 1
    s_mul_i32 s28, s7, 10
    s_min_u32 s29, s7, 8
    s_add_u32 s28, s28, s29
    s_lshl_b32 s28, s28, 13
    s_lshl_b32 s29, s6, 3
    s_add_u32 s29, s29, s4
    s_lshl_b32 s29, s29, 23
    s_add_u32 s28, s28, s29
    s_add_u32 s28, s28, 0x700000
    s_cmp_eq_u32 s4, 5
    s_cselect_b32 s94, 7, s4
    s_cmp_eq_u32 s4, 7
    s_cselect_b32 s94, 5, s94
    s_cmp_lt_u32 s7, 8
    s_cselect_b32 s35, 11, 10
    s_cmp_gt_u32 s3, 1
    s_cbranch_scc1 L_T
    s_cmp_eq_u32 s3, 1
    s_cbranch_scc1 L_X
    v_lshlrev_b32 v12, 2, v1
    v_xor_b32 v12, v12, v2
    v_lshlrev_b32 v12, 4, v12
    v_lshl_add_u32 v4, v1, 8, v12
    v_xor_b32 v5, 16, v4
    v_xor_b32 v6, 32, v4
    v_xor_b32 v7, 48, v4
    s_mov_b32 s31, 30720
    s_mov_b32 s32, 3
    s_mov_b32 s30, 9
    s_lshl_b32 s33, s35, 1
    s_sub_u32 s33, s33, 12
    s_setprio 3
    s_waitcnt lgkmcnt(0)
    s_load_dword s83, s[62:63], 0
    s_mov_b32 s8, s38
    s_mov_b32 s9, s39
    s_mov_b32 s10, 0x8000000
    s_mov_b32 s11, 0x00020000
    s_mov_b32 s12, s42
    s_mov_b32 s13, s43
    s_mov_b32 s14, 0x400000
    s_mov_b32 s15, 0x00020000
    s_cmp_eq_u32 s35, 10
    s_cbranch_scc1 L_k0
    s_sub_u32 s29, s5, 8
    s_lshl_b32 s29, s29, 18
    s_lshl_b32 s34, s4, 10
    s_add_u32 s29, s29, s34
    v_lshrrev_b32 v12, 3, v0
    v_and_b32 v13, 7, v0
    v_lshlrev_b32 v13, 7, v13
    v_lshl_add_u32 v12, v12, 13, v13
    buffer_load_dword v163, v12, s[12:15], s29 offen
    s_add_u32 s29, s29, 65536
    buffer_load_dword v163, v12, s[12:15], s29 offen
    s_add_u32 s29, s29, 65536
    buffer_load_dword v163, v12, s[12:15], s29 offen
    s_add_u32 s29, s29, 65536
    buffer_load_dword v163, v12, s[12:15], s29 offen
    s_add_u32 s29, s29, 65536
L_k0:
    s_mov_b32 m0, s31
    s_add_u32 s31, s31, 4096
    buffer_load_dwordx4 v4, s[8:11], s28 offen offset:0 nt lds
    buffer_load_dwordx4 v5, s[8:11], s28 offen offset:1024 nt lds
    buffer_load_dwordx4 v6, s[8:11], s28 offen offset:2048 nt lds
    buffer_load_dwordx4 v7, s[8:11], s28 offen offset:3072 nt lds
    s_add_u32 s28, s28, 4096
    s_sub_u32 s32, s32, 1
    s_cmp_lg_u32 s32, 0
    s_cbranch_scc1 L_k0
    s_barrier
L_k1:
    s_mov_b32 m0, s31
    s_add_u32 s31, s31, 4096
    buffer_load_dwordx4 v4, s[8:11], s28 offen offset:0 nt lds
    buffer_load_dwordx4 v5, s[8:11], s28 offen offset:1024 nt lds
    s_waitcnt vmcnt(22)
    buffer_load_dwordx4 v6, s[8:11], s28 offen offset:2048 nt lds
    buffer_load_dwordx4 v7, s[8:11], s28 offen offset:3072 nt lds
    s_waitcnt vmcnt(22)
    s_add_u32 s28, s28, 4096
    s_sub_u32 s30, s30, 1
    s_cmp_lg_u32 s30, 0
    s_cbranch_scc1 L_k1
    v_mov_b32 v30, 384
    ds_write_b32 v30, v30 offset:60
    v_mov_b32 v31, 4
    s_mov_b32 s12, s44
    s_mov_b32 s13, s45
    s_mov_b32 s14, 0x400000
    s_mov_b32 s15, 0x00020000
    s_mov_b32 s20, s56
    s_mov_b32 s21, s57
    s_mov_b32 s22, 0x300000
    s_mov_b32 s23, 0x00020000
    s_sub_u32 s32, s5, 8
    s_mul_i32 s29, s32, 22528
    s_min_u32 s29, s29, 499712
    s_lshl_b32 s30, s4, 19
    s_add_u32 s29, s29, s30
    v_lshlrev_b32 v27, 7, v0
    s_cmp_eq_u32 s35, 11
    s_cbranch_scc1 L_np10
    s_sub_u32 s29, s5, 24
    s_lshl_b32 s29, s29, 16
    s_add_u32 s29, s29, s30
    s_and_b32 s29, s29, 0xffff0000
    v_lshlrev_b32 v12, 10, v0
    buffer_load_dword v163, v12, s[12:15], s29 offen offset:384
L_np10:
    s_mul_i32 s29, s32, 22
    s_min_u32 s29, s29, 490
    s_mul_i32 s29, s29, 6144
    s_lshl_b32 s30, s4, 9
    s_add_u32 s29, s29, s30
    s_add_u32 s29, s29, 2048
    v_lshrrev_b32 v27, 2, v0
    v_min_u32 v12, 5, v27
    v_mul_u32_u24 v27, 6144, v27
    v_mul_u32_u24 v12, 6144, v12
    v_and_b32 v13, 3, v0
    v_lshl_add_u32 v27, v13, 7, v27
    v_lshl_add_u32 v12, v13, 7, v12
    s_add_u32 s30, s29, 98304
    buffer_load_dword v163, v27, s[20:23], s29 offen
    buffer_load_dword v163, v12, s[20:23], s30 offen
L_k2:
    s_mov_b32 m0, s31
    s_add_u32 s31, s31, 4096
    buffer_load_dwordx4 v4, s[8:11], s28 offen offset:0 nt lds
    buffer_load_dwordx4 v5, s[8:11], s28 offen offset:1024 nt lds
    s_waitcnt vmcnt(30)
    buffer_load_dwordx4 v6, s[8:11], s28 offen offset:2048 nt lds
    buffer_load_dwordx4 v7, s[8:11], s28 offen offset:3072 nt lds
    s_waitcnt vmcnt(30)
    v_add_u32 v31, 1, v31
    ds_write_b32 v30, v31 offset:48
    s_add_u32 s28, s28, 4096
    s_sub_u32 s33, s33, 1
    s_cmp_lg_u32 s33, 0
    s_cbranch_scc1 L_k2
    v_mov_b32 v30, 384
    ds_write_b32 v30, v30 offset:384
    s_waitcnt vmcnt(24)
    ds_write_b32 v30, v30 offset:388
    s_waitcnt vmcnt(16)
    ds_write_b32 v30, v30 offset:392
    s_waitcnt vmcnt(8)
    ds_write_b32 v30, v30 offset:396
    s_waitcnt vmcnt(0)
    ds_write_b32 v30, v30 offset:400
    s_branch L_H0
L_X:
    s_mov_b32 s3, 12
    s_cmp_eq_u32 s35, 11
    s_cbranch_scc1 L_T
    s_setprio 3
    s_and_b32 s6, s5, 1
    s_lshl_b32 s7, s4, 1
    s_add_u32 s6, s6, s7
    s_bfe_u32 s7, s5, 0x20001
    v_lshlrev_b32 v12, 3, v2
    v_and_b32 v13, 1, v1
    v_lshl_add_u32 v13, v13, 10, v12
    v_lshrrev_b32 v14, 5, v0
    v_lshl_add_u32 v61, v14, 7, v13
    s_lshl_b32 s28, s7, 8
    v_mul_u32_u24 v14, 98304, v1
    v_add_u32 v14, v14, v12
    s_mul_i32 s30, s7, 786432
    s_lshl_b32 s31, s6, 7
    s_add_u32 s30, s30, s31
    s_waitcnt lgkmcnt(0)
    s_load_dword s83, s[62:63], 0
    s_mov_b32 s20, s54
    s_mov_b32 s21, s55
    s_mov_b32 s22, 0x800
    s_mov_b32 s23, 0x00020000
    s_mov_b32 s8, s56
    s_mov_b32 s9, s57
    s_mov_b32 s10, 0x300000
    s_mov_b32 s11, 0x00020000
    buffer_load_dwordx2 v[52:53], v61, s[20:23], s28 offen
    s_add_u32 s29, s30, 0
    buffer_load_dwordx2 v[64:65], v14, s[8:11], s29 offen nt
    s_add_u32 s29, s30, 6144
    buffer_load_dwordx2 v[66:67], v14, s[8:11], s29 offen nt
    s_add_u32 s29, s30, 12288
    buffer_load_dwordx2 v[68:69], v14, s[8:11], s29 offen nt
    s_add_u32 s29, s30, 18432
    buffer_load_dwordx2 v[70:71], v14, s[8:11], s29 offen nt
    s_add_u32 s29, s30, 24576
    buffer_load_dwordx2 v[72:73], v14, s[8:11], s29 offen nt
    s_add_u32 s29, s30, 30720
    buffer_load_dwordx2 v[74:75], v14, s[8:11], s29 offen nt
    s_add_u32 s29, s30, 36864
    buffer_load_dwordx2 v[76:77], v14, s[8:11], s29 offen nt
    s_add_u32 s29, s30, 43008
    buffer_load_dwordx2 v[78:79], v14, s[8:11], s29 offen nt
    s_add_u32 s29, s30, 49152
    buffer_load_dwordx2 v[80:81], v14, s[8:11], s29 offen nt
    s_add_u32 s29, s30, 55296
    buffer_load_dwordx2 v[82:83], v14, s[8:11], s29 offen nt
    s_add_u32 s29, s30, 61440
    buffer_load_dwordx2 v[84:85], v14, s[8:11], s29 offen nt
    s_add_u32 s29, s30, 67584
    buffer_load_dwordx2 v[86:87], v14, s[8:11], s29 offen nt
    s_add_u32 s29, s30, 73728
    buffer_load_dwordx2 v[88:89], v14, s[8:11], s29 offen nt
    s_add_u32 s29, s30, 79872
    buffer_load_dwordx2 v[90:91], v14, s[8:11], s29 offen nt
    s_add_u32 s29, s30, 86016
    buffer_load_dwordx2 v[92:93], v14, s[8:11], s29 offen nt
    s_add_u32 s29, s30, 92160
    buffer_load_dwordx2 v[94:95], v14, s[8:11], s29 offen nt
    s_add_u32 s29, s30, 393216
    buffer_load_dwordx2 v[96:97], v14, s[8:11], s29 offen nt
    s_add_u32 s29, s30, 399360
    buffer_load_dwordx2 v[98:99], v14, s[8:11], s29 offen nt
    s_add_u32 s29, s30, 405504
    buffer_load_dwordx2 v[100:101], v14, s[8:11], s29 offen nt
    s_add_u32 s29, s30, 411648
    buffer_load_dwordx2 v[102:103], v14, s[8:11], s29 offen nt
    s_add_u32 s29, s30, 417792
    buffer_load_dwordx2 v[104:105], v14, s[8:11], s29 offen nt
    s_add_u32 s29, s30, 423936
    buffer_load_dwordx2 v[106:107], v14, s[8:11], s29 offen nt
    s_add_u32 s29, s30, 430080
    buffer_load_dwordx2 v[108:109], v14, s[8:11], s29 offen nt
    s_add_u32 s29, s30, 436224
    buffer_load_dwordx2 v[110:111], v14, s[8:11], s29 offen nt
    s_add_u32 s29, s30, 442368
    buffer_load_dwordx2 v[112:113], v14, s[8:11], s29 offen nt
    s_add_u32 s29, s30, 448512
    buffer_load_dwordx2 v[114:115], v14, s[8:11], s29 offen nt
    s_add_u32 s29, s30, 454656
    buffer_load_dwordx2 v[116:117], v14, s[8:11], s29 offen nt
    s_add_u32 s29, s30, 460800
    buffer_load_dwordx2 v[118:119], v14, s[8:11], s29 offen nt
    s_add_u32 s29, s30, 466944
    buffer_load_dwordx2 v[120:121], v14, s[8:11], s29 offen nt
    s_add_u32 s29, s30, 473088
    buffer_load_dwordx2 v[122:123], v14, s[8:11], s29 offen nt
    s_add_u32 s29, s30, 479232
    buffer_load_dwordx2 v[124:125], v14, s[8:11], s29 offen nt
    s_add_u32 s29, s30, 485376
    buffer_load_dwordx2 v[126:127], v14, s[8:11], s29 offen nt
    v_lshrrev_b32 v13, 2, v2
    v_mul_u32_u24 v25, 48, v13
    v_mov_b32 v16, 0
    v_mov_b32 v17, 0
    v_mov_b32 v18, 0
    v_mov_b32 v19, 0
    v_mov_b32 v20, 0xff800000
    v_add_u32 v29, 112640, v3
    v_mov_b32 v63, 384
    ds_write_b32 v25, v20 offset:40
    ds_write_b32 v25, v16 offset:232
    ds_write_b128 v29, v[16:19]
    ds_write_b128 v29, v[16:19] offset:1024
    ds_write_b32 v63, v63 offset:40
    ds_write_b32 v63, v63 offset:104
    s_waitcnt lgkmcnt(0)
    s_barrier
    s_mov_b32 s16, s62
    s_mov_b32 s17, s63
    s_mov_b32 s18, 0x400000
    s_mov_b32 s19, 0x00020000
    v_and_b32 v12, 1, v2
    v_cmp_eq_u32 vcc, 1, v12
    v_mov_b32 v13, 0x0c0c0100
    v_mov_b32 v14, 0x01000c0c
    v_cndmask_b32 v13, v13, v14, vcc
    v_mov_b32 v14, 0x0c0c0302
    v_mov_b32 v15, 0x03020c0c
    v_cndmask_b32 v14, v14, v15, vcc
    v_and_b32 v12, 2, v2
    v_cmp_eq_u32 vcc, 2, v12
    v_mov_b32 v15, 0x0c0c0c0c
    s_nop 0
    v_cndmask_b32 v4, v13, v15, vcc
    v_cndmask_b32 v5, v15, v13, vcc
    v_cndmask_b32 v6, v14, v15, vcc
    v_cndmask_b32 v7, v15, v14, vcc
    s_waitcnt lgkmcnt(0)
    s_mul_i32 s68, s83, 1664525
    s_add_u32 s68, s68, 1013904223
    s_and_b32 s64, s68, 0xff
    s_bfe_u32 s65, s68, 0x70009
    s_lshl_b32 s65, s65, 1
    s_andn2_b32 s66, 1, s68
    s_or_b32 s65, s65, s66
    s_bfe_u32 s66, s68, 0x80010
    s_lshr_b32 s67, s68, 24
    v_mov_b32 v8, s64
    v_mov_b32 v9, s65
    v_mov_b32 v10, s66
    v_mov_b32 v11, s67
    v_and_b32 v60, 31, v0
    v_lshlrev_b32 v60, 4, v60
    s_lshl_b32 s73, s6, 2
    s_add_u32 s73, s73, s7
    s_lshl_b32 s73, s73, 10
    s_add_u32 s73, s73, 65536
    s_mov_b32 s34, 0
    s_mov_b32 s35, -1
    v_lshlrev_b32 v58, 3, v0
    v_bfe_u32 v59, v2, 2, 1
    v_lshlrev_b32 v59, 7, v59
    v_lshl_add_u32 v59, v1, 5, v59
    s_waitcnt vmcnt(32)
    v_lshlrev_b32 v32, 16, v52
    v_and_b32 v33, s70, v52
    v_lshlrev_b32 v34, 16, v53
    v_and_b32 v35, s70, v53
    v_mul_f32 v36, 0xbfb8aa3b, v32
    v_mul_f32 v37, 0xbfb8aa3b, v33
    v_mul_f32 v38, 0xbfb8aa3b, v34
    v_mul_f32 v39, 0xbfb8aa3b, v35
    v_exp_f32 v36, v36
    v_exp_f32 v37, v37
    v_exp_f32 v38, v38
    v_exp_f32 v39, v39
    v_add_f32 v36, 1.0, v36
    v_add_f32 v37, 1.0, v37
    v_add_f32 v38, 1.0, v38
    v_add_f32 v39, 1.0, v39
    v_rcp_f32 v36, v36
    v_rcp_f32 v37, v37
    v_rcp_f32 v38, v38
    v_rcp_f32 v39, v39
    v_mul_f32 v32, v32, v36
    v_mul_f32 v33, v33, v37
    v_mul_f32 v34, v34, v38
    v_mul_f32 v35, v35, v39
    v_cvt_pk_bf16_f32 v56, v32, v33
    v_cvt_pk_bf16_f32 v57, v34, v35
    ds_write_b64 v58, v[56:57] offset:5120
    ds_read_b128 v[16:19], v59 offset:5120
    ds_read_b128 v[20:23], v59 offset:5136
    ds_read_b128 v[24:27], v59 offset:5376
    ds_read_b128 v[28:31], v59 offset:5392
    s_waitcnt lgkmcnt(0)
    v_perm_b32 v32, v16, v16, v4
    v_perm_b32 v33, v16, v16, v5
    v_perm_b32 v34, v16, v16, v6
    v_perm_b32 v35, v16, v16, v7
    v_perm_b32 v36, v17, v17, v4
    v_perm_b32 v37, v17, v17, v5
    v_perm_b32 v38, v17, v17, v6
    v_perm_b32 v39, v17, v17, v7
    s_waitcnt vmcnt(30)
    v_mfma_f32_16x16x32_bf16 v[44:47], v[32:35], v[64:67], 0
    v_perm_b32 v40, v18, v18, v4
    v_perm_b32 v41, v18, v18, v5
    v_perm_b32 v42, v18, v18, v6
    v_perm_b32 v43, v18, v18, v7
    s_waitcnt vmcnt(28)
    v_mfma_f32_16x16x32_bf16 v[44:47], v[36:39], v[68:71], v[44:47]
    v_perm_b32 v32, v19, v19, v4
    v_perm_b32 v33, v19, v19, v5
    v_perm_b32 v34, v19, v19, v6
    v_perm_b32 v35, v19, v19, v7
    s_waitcnt vmcnt(26)
    v_mfma_f32_16x16x32_bf16 v[44:47], v[40:43], v[72:75], v[44:47]
    v_perm_b32 v36, v20, v20, v4
    v_perm_b32 v37, v20, v20, v5
    v_perm_b32 v38, v20, v20, v6
    v_perm_b32 v39, v20, v20, v7
    s_waitcnt vmcnt(24)
    v_mfma_f32_16x16x32_bf16 v[44:47], v[32:35], v[76:79], v[44:47]
    v_perm_b32 v40, v21, v21, v4
    v_perm_b32 v41, v21, v21, v5
    v_perm_b32 v42, v21, v21, v6
    v_perm_b32 v43, v21, v21, v7
    s_waitcnt vmcnt(22)
    v_mfma_f32_16x16x32_bf16 v[44:47], v[36:39], v[80:83], v[44:47]
    v_perm_b32 v32, v22, v22, v4
    v_perm_b32 v33, v22, v22, v5
    v_perm_b32 v34, v22, v22, v6
    v_perm_b32 v35, v22, v22, v7
    s_waitcnt vmcnt(20)
    v_mfma_f32_16x16x32_bf16 v[44:47], v[40:43], v[84:87], v[44:47]
    v_perm_b32 v36, v23, v23, v4
    v_perm_b32 v37, v23, v23, v5
    v_perm_b32 v38, v23, v23, v6
    v_perm_b32 v39, v23, v23, v7
    s_waitcnt vmcnt(18)
    v_mfma_f32_16x16x32_bf16 v[44:47], v[32:35], v[88:91], v[44:47]
    v_perm_b32 v40, v24, v24, v4
    v_perm_b32 v41, v24, v24, v5
    v_perm_b32 v42, v24, v24, v6
    v_perm_b32 v43, v24, v24, v7
    s_waitcnt vmcnt(16)
    v_mfma_f32_16x16x32_bf16 v[44:47], v[36:39], v[92:95], v[44:47]
    v_perm_b32 v32, v25, v25, v4
    v_perm_b32 v33, v25, v25, v5
    v_perm_b32 v34, v25, v25, v6
    v_perm_b32 v35, v25, v25, v7
    s_waitcnt vmcnt(14)
    v_mfma_f32_16x16x32_bf16 v[44:47], v[40:43], v[96:99], v[44:47]
    v_perm_b32 v36, v26, v26, v4
    v_perm_b32 v37, v26, v26, v5
    v_perm_b32 v38, v26, v26, v6
    v_perm_b32 v39, v26, v26, v7
    s_waitcnt vmcnt(12)
    v_mfma_f32_16x16x32_bf16 v[44:47], v[32:35], v[100:103], v[44:47]
    v_perm_b32 v40, v27, v27, v4
    v_perm_b32 v41, v27, v27, v5
    v_perm_b32 v42, v27, v27, v6
    v_perm_b32 v43, v27, v27, v7
    s_waitcnt vmcnt(10)
    v_mfma_f32_16x16x32_bf16 v[44:47], v[36:39], v[104:107], v[44:47]
    v_perm_b32 v32, v28, v28, v4
    v_perm_b32 v33, v28, v28, v5
    v_perm_b32 v34, v28, v28, v6
    v_perm_b32 v35, v28, v28, v7
    s_waitcnt vmcnt(8)
    v_mfma_f32_16x16x32_bf16 v[44:47], v[40:43], v[108:111], v[44:47]
    v_perm_b32 v36, v29, v29, v4
    v_perm_b32 v37, v29, v29, v5
    v_perm_b32 v38, v29, v29, v6
    v_perm_b32 v39, v29, v29, v7
    s_waitcnt vmcnt(6)
    v_mfma_f32_16x16x32_bf16 v[44:47], v[32:35], v[112:115], v[44:47]
    v_perm_b32 v40, v30, v30, v4
    v_perm_b32 v41, v30, v30, v5
    v_perm_b32 v42, v30, v30, v6
    v_perm_b32 v43, v30, v30, v7
    s_waitcnt vmcnt(4)
    v_mfma_f32_16x16x32_bf16 v[44:47], v[36:39], v[116:119], v[44:47]
    v_perm_b32 v32, v31, v31, v4
    v_perm_b32 v33, v31, v31, v5
    v_perm_b32 v34, v31, v31, v6
    v_perm_b32 v35, v31, v31, v7
    s_waitcnt vmcnt(2)
    v_mfma_f32_16x16x32_bf16 v[44:47], v[40:43], v[120:123], v[44:47]
    s_waitcnt vmcnt(0)
    v_mfma_f32_16x16x32_bf16 v[44:47], v[32:35], v[124:127], v[44:47]
    s_nop 7
    v_and_b32 v48, s69, v44
    v_and_b32 v49, s69, v45
    v_and_b32 v50, s69, v46
    v_and_b32 v51, s69, v47
    v_sub_f32 v48, v44, v48
    v_sub_f32 v49, v45, v49
    v_sub_f32 v50, v46, v50
    v_sub_f32 v51, v47, v51
    v_cndmask_b32 v44, v44, v48, s[34:35]
    v_cndmask_b32 v45, v45, v49, s[34:35]
    v_cndmask_b32 v46, v46, v50, s[34:35]
    v_cndmask_b32 v47, v47, v51, s[34:35]
    v_and_or_b32 v44, v44, s69, v8
    v_and_or_b32 v45, v45, s69, v9
    v_and_or_b32 v46, v46, s69, v10
    v_and_or_b32 v47, v47, s69, v11
    buffer_store_dwordx4 v[44:47], v3, s[16:19], s73 offen sc1
    ds_write_b32 v63, v63 offset:60
    s_branch L_X2
L_exit0:
    s_endpgm
L_W:
    s_cmp_eq_u32 s3, 11
    s_cbranch_scc1 L_exit0
    s_cmp_eq_u32 s3, 8
    s_cbranch_scc1 L_exit0
    s_cmp_ge_u32 s3, 8
    s_cbranch_scc1 L_Wx
    v_lshlrev_b32 v12, 3, v2
    v_and_b32 v14, 1, v1
    v_lshl_add_u32 v12, v14, 10, v12
    v_lshrrev_b32 v15, 5, v0
    v_lshl_add_u32 v12, v15, 2, v12
    s_lshl_b32 s32, s3, 7
    v_lshlrev_b32 v14, 10, v14
    v_lshl_add_u32 v14, v15, 9, v14
    v_lshl_add_u32 v14, v2, 5, v14
    v_and_b32 v60, 31, v0
    v_lshlrev_b32 v53, 1, v60
    v_lshl_add_u32 v13, v15, 10, v53
    s_lshr_b32 s7, s5, 2
    s_lshl_b32 s7, s7, 8
    s_lshl_b32 s29, s3, 5
    s_add_u32 s7, s7, s29
    s_lshl_b32 s29, s7, 1
    s_waitcnt lgkmcnt(0)
    s_load_dword s83, s[62:63], 0
    s_mov_b32 s24, s36
    s_mov_b32 s25, s37
    s_mov_b32 s26, 0x800
    s_mov_b32 s27, 0x00020000
    s_mov_b32 s20, s54
    s_mov_b32 s21, s55
    s_mov_b32 s22, 0x800
    s_mov_b32 s23, 0x00020000
    buffer_load_dword v54, v12, s[24:27], s32 offen
    buffer_load_dwordx4 v[112:115], v14, s[24:27], 0 offen
    buffer_load_dwordx4 v[116:119], v14, s[24:27], 0 offen offset:16
    buffer_load_ushort v55, v13, s[20:23], s29 offen
    v_lshl_add_u32 v53, v15, 6, v53
    s_mov_b32 s12, s42
    s_mov_b32 s13, s43
    s_mov_b32 s14, 0x400000
    s_mov_b32 s15, 0x00020000
    v_lshrrev_b32 v14, 3, v2
    v_lshl_add_u32 v14, v1, 4, v14
    v_mul_u32_u24 v14, 8192, v14
    v_and_b32 v52, 7, v2
    v_lshl_add_u32 v52, v52, 4, v14
    s_lshl_b32 s31, s3, 19
    s_lshl_b32 s29, s4, 10
    s_add_u32 s31, s31, s29
    s_lshl_b32 s29, s5, 7
    s_add_u32 s31, s31, s29
    s_cmp_ge_u32 s3, 0
    s_cbranch_scc1 L_nw1
    s_add_u32 s29, s31, 0
    buffer_load_dwordx4 v[64:67], v52, s[12:15], s29 offen nt
    s_add_u32 s29, s31, 16384
    buffer_load_dwordx4 v[68:71], v52, s[12:15], s29 offen nt
    s_add_u32 s29, s31, 32768
    buffer_load_dwordx4 v[72:75], v52, s[12:15], s29 offen nt
    s_add_u32 s29, s31, 49152
    buffer_load_dwordx4 v[76:79], v52, s[12:15], s29 offen nt
    s_add_u32 s29, s31, 65536
    buffer_load_dwordx4 v[80:83], v52, s[12:15], s29 offen nt
    s_add_u32 s29, s31, 81920
    buffer_load_dwordx4 v[84:87], v52, s[12:15], s29 offen nt
    s_add_u32 s29, s31, 98304
    buffer_load_dwordx4 v[88:91], v52, s[12:15], s29 offen nt
    s_add_u32 s29, s31, 114688
    buffer_load_dwordx4 v[92:95], v52, s[12:15], s29 offen nt
L_nw1:
    s_mov_b32 s16, s62
    s_mov_b32 s17, s63
    s_mov_b32 s18, 0x400000
    s_mov_b32 s19, 0x00020000
    s_mov_b32 s88, 0x05040100
    s_mov_b32 s89, 0x07060302
    s_lshl_b32 s28, s3, 9
    s_add_u32 s28, s28, 1024
    v_and_b32 v58, 31, v0
    v_lshlrev_b32 v58, 3, v58
    v_lshrrev_b32 v59, 5, v0
    v_lshl_add_u32 v58, v59, 2, v58
    v_add_u32 v56, 512, v58
    v_and_b32 v56, -8, v56
    v_add_u32 v58, s28, v58
    v_and_b32 v57, 1, v1
    v_lshlrev_b32 v57, 7, v57
    v_lshl_add_u32 v57, v59, 3, v57
    s_lshl_b32 s29, s3, 4
    s_add_u32 s29, s29, 512
    v_add_u32 v57, s29, v57
    v_bfe_u32 v59, v2, 2, 1
    v_lshlrev_b32 v59, 7, v59
    v_lshl_add_u32 v59, v1, 5, v59
    v_add_u32 v59, s28, v59
    v_add_u32 v53, s28, v53
    v_lshlrev_b32 v60, 4, v60
    s_lshl_b32 s29, s3, 9
    s_add_u32 s29, s29, 6144
    v_add_u32 v20, s29, v60
    v_add_u32 v62, 4096, v20
    v_add_u32 v63, 8192, v20
    v_lshrrev_b32 v61, 5, v0
    v_lshl_add_u32 v61, v61, 15, v60
    s_lshl_b32 s30, s3, 12
    s_add_u32 s30, s30, 65536
    s_waitcnt lgkmcnt(0)
    s_mul_i32 s68, s83, 1664525
    s_add_u32 s68, s68, 1013904223
    s_and_b32 s64, s68, 0xff
    s_bfe_u32 s65, s68, 0x70009
    s_lshl_b32 s65, s65, 1
    s_andn2_b32 s66, 1, s68
    s_or_b32 s65, s65, s66
    s_bfe_u32 s66, s68, 0x80010
    s_lshr_b32 s67, s68, 24
    v_mov_b32 v8, s64
    v_mov_b32 v9, s65
    v_mov_b32 v10, s66
    v_mov_b32 v11, s67
    s_waitcnt vmcnt(8)
    s_cmp_lt_u32 s3, 0
    s_cbranch_scc1 L_nw2
    s_waitcnt vmcnt(0)
L_nw2:
    v_lshlrev_b32 v164, 16, v54
    v_and_b32 v165, s70, v54
    v_lshlrev_b32 v96, 16, v112
    v_and_b32 v97, s70, v112
    v_lshlrev_b32 v98, 16, v113
    v_and_b32 v99, s70, v113
    v_lshlrev_b32 v100, 16, v114
    v_and_b32 v101, s70, v114
    v_lshlrev_b32 v102, 16, v115
    v_and_b32 v103, s70, v115
    v_lshlrev_b32 v104, 16, v116
    v_and_b32 v105, s70, v116
    v_lshlrev_b32 v106, 16, v117
    v_and_b32 v107, s70, v117
    v_lshlrev_b32 v108, 16, v118
    v_and_b32 v109, s70, v118
    v_lshlrev_b32 v110, 16, v119
    v_and_b32 v111, s70, v119
    v_pk_add_f32 v[112:113], v[96:97], v[104:105]
    v_pk_add_f32 v[114:115], v[98:99], v[106:107]
    v_pk_add_f32 v[116:117], v[100:101], v[108:109]
    v_pk_add_f32 v[118:119], v[102:103], v[110:111]
    v_pk_add_f32 v[112:113], v[112:113], v[116:117]
    v_pk_add_f32 v[114:115], v[114:115], v[118:119]
    v_pk_add_f32 v[112:113], v[112:113], v[114:115]
    v_add_f32 v36, v112, v113
    s_nop 1
    v_add_f32_dpp v36, v36, v36 row_ror:8 row_mask:0xf bank_mask:0xf
    s_nop 1
    v_add_f32_dpp v36, v36, v36 row_ror:4 row_mask:0xf bank_mask:0xf
    s_nop 1
    v_add_f32_dpp v36, v36, v36 row_ror:2 row_mask:0xf bank_mask:0xf
    s_nop 1
    v_add_f32_dpp v36, v36, v36 row_ror:1 row_mask:0xf bank_mask:0xf
    v_mov_b32 v40, v36
    s_nop 1
    v_permlane32_swap_b32 v36, v40
    v_add_f32 v36, v36, v40
    v_mul_f32 v36, 0x3b000000, v36
    v_pk_add_f32 v[96:97], v[96:97], v[36:37] op_sel_hi:[1,0] neg_lo:[0,1] neg_hi:[0,1]
    v_pk_add_f32 v[98:99], v[98:99], v[36:37] op_sel_hi:[1,0] neg_lo:[0,1] neg_hi:[0,1]
    v_pk_add_f32 v[100:101], v[100:101], v[36:37] op_sel_hi:[1,0] neg_lo:[0,1] neg_hi:[0,1]
    v_pk_add_f32 v[102:103], v[102:103], v[36:37] op_sel_hi:[1,0] neg_lo:[0,1] neg_hi:[0,1]
    v_pk_add_f32 v[104:105], v[104:105], v[36:37] op_sel_hi:[1,0] neg_lo:[0,1] neg_hi:[0,1]
    v_pk_add_f32 v[106:107], v[106:107], v[36:37] op_sel_hi:[1,0] neg_lo:[0,1] neg_hi:[0,1]
    v_pk_add_f32 v[108:109], v[108:109], v[36:37] op_sel_hi:[1,0] neg_lo:[0,1] neg_hi:[0,1]
    v_pk_add_f32 v[110:111], v[110:111], v[36:37] op_sel_hi:[1,0] neg_lo:[0,1] neg_hi:[0,1]
    v_pk_mul_f32 v[96:97], v[96:97], v[96:97]
    v_pk_mul_f32 v[98:99], v[98:99], v[98:99]
    v_pk_mul_f32 v[100:101], v[100:101], v[100:101]
    v_pk_mul_f32 v[102:103], v[102:103], v[102:103]
    v_pk_mul_f32 v[104:105], v[104:105], v[104:105]
    v_pk_mul_f32 v[106:107], v[106:107], v[106:107]
    v_pk_mul_f32 v[108:109], v[108:109], v[108:109]
    v_pk_mul_f32 v[110:111], v[110:111], v[110:111]
    v_pk_add_f32 v[112:113], v[96:97], v[104:105]
    v_pk_add_f32 v[114:115], v[98:99], v[106:107]
    v_pk_add_f32 v[116:117], v[100:101], v[108:109]
    v_pk_add_f32 v[118:119], v[102:103], v[110:111]
    v_pk_add_f32 v[112:113], v[112:113], v[116:117]
    v_pk_add_f32 v[114:115], v[114:115], v[118:119]
    v_pk_add_f32 v[112:113], v[112:113], v[114:115]
    v_add_f32 v37, v112, v113
    s_nop 1
    v_add_f32_dpp v37, v37, v37 row_ror:8 row_mask:0xf bank_mask:0xf
    s_nop 1
    v_add_f32_dpp v37, v37, v37 row_ror:4 row_mask:0xf bank_mask:0xf
    s_nop 1
    v_add_f32_dpp v37, v37, v37 row_ror:2 row_mask:0xf bank_mask:0xf
    s_nop 1
    v_add_f32_dpp v37, v37, v37 row_ror:1 row_mask:0xf bank_mask:0xf
    v_mov_b32 v40, v37
    s_nop 1
    v_permlane32_swap_b32 v37, v40
    v_add_f32 v37, v37, v40
    v_mul_f32 v37, 0x3b000000, v37
    v_cvt_pk_bf16_f32 v38, v36, v37
    v_lshlrev_b32 v36, 16, v38
    v_and_b32 v37, s70, v38
    v_add_f32 v38, 0x3727c5ac, v37
    v_pk_add_f32 v[16:17], v[164:165], v[36:37] op_sel_hi:[1,0] neg_lo:[0,1] neg_hi:[0,1]
    v_cvt_pk_bf16_f32 v38, v38, v38
    v_cvt_pk_bf16_f32 v39, v16, v17
    v_and_b32 v38, s70, v38
    v_sqrt_f32 v38, v38
    v_lshlrev_b32 v16, 16, v39
    v_and_b32 v17, s70, v39
    v_cvt_pk_bf16_f32 v38, v38, v38
    v_and_b32 v38, s70, v38
    v_rcp_f32 v38, v38
    s_nop 0
    v_pk_mul_f32 v[16:17], v[16:17], v[38:39] op_sel_hi:[1,0]
    v_cvt_pk_bf16_f32 v39, v16, v17
    v_lshlrev_b32 v16, 16, v39
    v_and_b32 v17, s70, v39
    s_cmp_lt_u32 s3, 0
    s_cbranch_scc1 L_nw3
    s_add_u32 s29, s31, 0
    buffer_load_dwordx4 v[64:67], v52, s[12:15], s29 offen nt
    s_add_u32 s29, s31, 16384
    buffer_load_dwordx4 v[68:71], v52, s[12:15], s29 offen nt
    s_add_u32 s29, s31, 32768
    buffer_load_dwordx4 v[72:75], v52, s[12:15], s29 offen nt
    s_add_u32 s29, s31, 49152
    buffer_load_dwordx4 v[76:79], v52, s[12:15], s29 offen nt
    s_add_u32 s29, s31, 65536
    buffer_load_dwordx4 v[80:83], v52, s[12:15], s29 offen nt
    s_add_u32 s29, s31, 81920
    buffer_load_dwordx4 v[84:87], v52, s[12:15], s29 offen nt
    s_add_u32 s29, s31, 98304
    buffer_load_dwordx4 v[88:91], v52, s[12:15], s29 offen nt
    s_add_u32 s29, s31, 114688
    buffer_load_dwordx4 v[92:95], v52, s[12:15], s29 offen nt
L_nw3:
    s_mov_b32 s8, s44
    s_mov_b32 s9, s45
    s_mov_b32 s10, 0x400000
    s_mov_b32 s11, 0x00020000
    v_lshrrev_b32 v12, 3, v2
    v_and_b32 v15, 7, v2
    v_lshlrev_b32 v15, 4, v15
    v_lshl_add_u32 v21, v1, 2, v12
    v_lshl_add_u32 v21, v21, 13, v15
    s_lshl_b32 s91, s4, 9
    s_lshr_b32 s28, s3, 1
    s_lshl_b32 s29, s28, 7
    s_add_u32 s91, s91, s29
    s_and_b32 s29, s3, 1
    s_add_u32 s91, s91, s29
    s_lshl_b32 s91, s91, 10
    s_lshl_b32 s29, s5, 7
    s_add_u32 s91, s91, s29
    v_lshlrev_b32 v32, 16, v55
    v_mul_f32 v36, 0xbfb8aa3b, v32
    v_exp_f32 v36, v36
    s_nop 0
    v_add_f32 v36, 1.0, v36
    v_rcp_f32 v36, v36
    s_nop 0
    v_mul_f32 v32, v32, v36
    v_cvt_pk_bf16_f32 v32, v32, v32
    ds_write_b16 v53, v32 offset:256
    s_waitcnt vmcnt(7)
    v_mov_b32 v36, v64
    v_mov_b32 v37, v65
    v_mov_b32_dpp v64, v66 row_ror:8 row_mask:0xf bank_mask:0xc
    v_mov_b32_dpp v65, v67 row_ror:8 row_mask:0xf bank_mask:0xc
    v_mov_b32_dpp v66, v36 row_ror:8 row_mask:0xf bank_mask:0x3
    v_mov_b32_dpp v67, v37 row_ror:8 row_mask:0xf bank_mask:0x3
    v_perm_b32 v128, v66, v64, s88
    v_perm_b32 v132, v66, v64, s89
    v_perm_b32 v136, v67, v65, s88
    v_perm_b32 v140, v67, v65, s89
    s_waitcnt vmcnt(6)
    v_mov_b32 v36, v68
    v_mov_b32 v37, v69
    v_mov_b32_dpp v68, v70 row_ror:8 row_mask:0xf bank_mask:0xc
    v_mov_b32_dpp v69, v71 row_ror:8 row_mask:0xf bank_mask:0xc
    v_mov_b32_dpp v70, v36 row_ror:8 row_mask:0xf bank_mask:0x3
    v_mov_b32_dpp v71, v37 row_ror:8 row_mask:0xf bank_mask:0x3
    v_perm_b32 v129, v70, v68, s88
    v_perm_b32 v133, v70, v68, s89
    v_perm_b32 v137, v71, v69, s88
    v_perm_b32 v141, v71, v69, s89
    s_waitcnt vmcnt(5)
    v_mov_b32 v36, v72
    v_mov_b32 v37, v73
    v_mov_b32_dpp v72, v74 row_ror:8 row_mask:0xf bank_mask:0xc
    v_mov_b32_dpp v73, v75 row_ror:8 row_mask:0xf bank_mask:0xc
    v_mov_b32_dpp v74, v36 row_ror:8 row_mask:0xf bank_mask:0x3
    v_mov_b32_dpp v75, v37 row_ror:8 row_mask:0xf bank_mask:0x3
    v_perm_b32 v130, v74, v72, s88
    v_perm_b32 v134, v74, v72, s89
    v_perm_b32 v138, v75, v73, s88
    v_perm_b32 v142, v75, v73, s89
    s_waitcnt vmcnt(4)
    v_mov_b32 v36, v76
    v_mov_b32 v37, v77
    v_mov_b32_dpp v76, v78 row_ror:8 row_mask:0xf bank_mask:0xc
    v_mov_b32_dpp v77, v79 row_ror:8 row_mask:0xf bank_mask:0xc
    v_mov_b32_dpp v78, v36 row_ror:8 row_mask:0xf bank_mask:0x3
    v_mov_b32_dpp v79, v37 row_ror:8 row_mask:0xf bank_mask:0x3
    v_perm_b32 v131, v78, v76, s88
    v_perm_b32 v135, v78, v76, s89
    v_perm_b32 v139, v79, v77, s88
    v_perm_b32 v143, v79, v77, s89
    s_waitcnt vmcnt(3)
    v_mov_b32 v36, v80
    v_mov_b32 v37, v81
    v_mov_b32_dpp v80, v82 row_ror:8 row_mask:0xf bank_mask:0xc
    v_mov_b32_dpp v81, v83 row_ror:8 row_mask:0xf bank_mask:0xc
    v_mov_b32_dpp v82, v36 row_ror:8 row_mask:0xf bank_mask:0x3
    v_mov_b32_dpp v83, v37 row_ror:8 row_mask:0xf bank_mask:0x3
    v_perm_b32 v144, v82, v80, s88
    v_perm_b32 v148, v82, v80, s89
    v_perm_b32 v152, v83, v81, s88
    v_perm_b32 v156, v83, v81, s89
    s_waitcnt vmcnt(2)
    v_mov_b32 v36, v84
    v_mov_b32 v37, v85
    v_mov_b32_dpp v84, v86 row_ror:8 row_mask:0xf bank_mask:0xc
    v_mov_b32_dpp v85, v87 row_ror:8 row_mask:0xf bank_mask:0xc
    v_mov_b32_dpp v86, v36 row_ror:8 row_mask:0xf bank_mask:0x3
    v_mov_b32_dpp v87, v37 row_ror:8 row_mask:0xf bank_mask:0x3
    v_perm_b32 v145, v86, v84, s88
    v_perm_b32 v149, v86, v84, s89
    v_perm_b32 v153, v87, v85, s88
    v_perm_b32 v157, v87, v85, s89
    s_waitcnt vmcnt(1)
    v_mov_b32 v36, v88
    v_mov_b32 v37, v89
    v_mov_b32_dpp v88, v90 row_ror:8 row_mask:0xf bank_mask:0xc
    v_mov_b32_dpp v89, v91 row_ror:8 row_mask:0xf bank_mask:0xc
    v_mov_b32_dpp v90, v36 row_ror:8 row_mask:0xf bank_mask:0x3
    v_mov_b32_dpp v91, v37 row_ror:8 row_mask:0xf bank_mask:0x3
    v_perm_b32 v146, v90, v88, s88
    v_perm_b32 v150, v90, v88, s89
    v_perm_b32 v154, v91, v89, s88
    v_perm_b32 v158, v91, v89, s89
    s_waitcnt vmcnt(0)
    v_mov_b32 v36, v92
    v_mov_b32 v37, v93
    v_mov_b32_dpp v92, v94 row_ror:8 row_mask:0xf bank_mask:0xc
    v_mov_b32_dpp v93, v95 row_ror:8 row_mask:0xf bank_mask:0xc
    v_mov_b32_dpp v94, v36 row_ror:8 row_mask:0xf bank_mask:0x3
    v_mov_b32_dpp v95, v37 row_ror:8 row_mask:0xf bank_mask:0x3
    v_perm_b32 v147, v94, v92, s88
    v_perm_b32 v151, v94, v92, s89
    v_perm_b32 v155, v95, v93, s88
    v_perm_b32 v159, v95, v93, s89
    s_barrier
L_Q:
    s_mov_b32 s71, 65535
    s_mov_b32 s33, 255
    s_cbranch_execz L_spx3
    buffer_load_dwordx4 v[96:99], v61, s[16:19], s30 offen offset:0 sc1
    buffer_load_dwordx4 v[100:103], v61, s[16:19], s30 offen offset:512 sc1
    buffer_load_dwordx4 v[104:107], v61, s[16:19], s30 offen offset:1024 sc1
    buffer_load_dwordx4 v[108:111], v61, s[16:19], s30 offen offset:1536 sc1
    buffer_load_dwordx4 v[112:115], v61, s[16:19], s30 offen offset:2048 sc1
    buffer_load_dwordx4 v[116:119], v61, s[16:19], s30 offen offset:2560 sc1
    buffer_load_dwordx4 v[120:123], v61, s[16:19], s30 offen offset:3072 sc1
    buffer_load_dwordx4 v[124:127], v61, s[16:19], s30 offen offset:3584 sc1
L_sp1:
    s_sub_u32 s71, s71, 1
    s_cbranch_scc1 L_spd2
    s_waitcnt vmcnt(0)
L_spx3:
    s_bitcmp1_b32 s33, 0
    s_cbranch_scc0 L_sc5
    v_xor_b32 v96, s64, v96
    v_xor_b32 v97, s65, v97
    v_xor_b32 v98, s66, v98
    v_xor_b32 v99, s67, v99
    v_or3_b32 v32, v96, v97, v98
    v_bitop3_b32 v32, v32, v99, s69 bitop3:0x54
    v_cmp_ne_u32 vcc, 0, v32
    s_cbranch_vccz L_sr6
    s_cbranch_execz L_sr6
    buffer_load_dwordx4 v[96:99], v61, s[16:19], s30 offen offset:0 sc1
    s_branch L_sc5
L_sr6:
    s_bitset0_b32 s33, 0
L_sc5:
    s_bitcmp1_b32 s33, 1
    s_cbranch_scc0 L_sc7
    v_xor_b32 v100, s64, v100
    v_xor_b32 v101, s65, v101
    v_xor_b32 v102, s66, v102
    v_xor_b32 v103, s67, v103
    v_or3_b32 v32, v100, v101, v102
    v_bitop3_b32 v32, v32, v103, s69 bitop3:0x54
    v_cmp_ne_u32 vcc, 0, v32
    s_cbranch_vccz L_sr8
    s_cbranch_execz L_sr8
    buffer_load_dwordx4 v[100:103], v61, s[16:19], s30 offen offset:512 sc1
    s_branch L_sc7
L_sr8:
    s_bitset0_b32 s33, 1
L_sc7:
    s_bitcmp1_b32 s33, 2
    s_cbranch_scc0 L_sc9
    v_xor_b32 v104, s64, v104
    v_xor_b32 v105, s65, v105
    v_xor_b32 v106, s66, v106
    v_xor_b32 v107, s67, v107
    v_or3_b32 v32, v104, v105, v106
    v_bitop3_b32 v32, v32, v107, s69 bitop3:0x54
    v_cmp_ne_u32 vcc, 0, v32
    s_cbranch_vccz L_sr10
    s_cbranch_execz L_sr10
    buffer_load_dwordx4 v[104:107], v61, s[16:19], s30 offen offset:1024 sc1
    s_branch L_sc9
L_sr10:
    s_bitset0_b32 s33, 2
L_sc9:
    s_bitcmp1_b32 s33, 3
    s_cbranch_scc0 L_sc11
    v_xor_b32 v108, s64, v108
    v_xor_b32 v109, s65, v109
    v_xor_b32 v110, s66, v110
    v_xor_b32 v111, s67, v111
    v_or3_b32 v32, v108, v109, v110
    v_bitop3_b32 v32, v32, v111, s69 bitop3:0x54
    v_cmp_ne_u32 vcc, 0, v32
    s_cbranch_vccz L_sr12
    s_cbranch_execz L_sr12
    buffer_load_dwordx4 v[108:111], v61, s[16:19], s30 offen offset:1536 sc1
    s_branch L_sc11
L_sr12:
    s_bitset0_b32 s33, 3
L_sc11:
    s_bitcmp1_b32 s33, 4
    s_cbranch_scc0 L_sc13
    v_xor_b32 v112, s64, v112
    v_xor_b32 v113, s65, v113
    v_xor_b32 v114, s66, v114
    v_xor_b32 v115, s67, v115
    v_or3_b32 v32, v112, v113, v114
    v_bitop3_b32 v32, v32, v115, s69 bitop3:0x54
    v_cmp_ne_u32 vcc, 0, v32
    s_cbranch_vccz L_sr14
    s_cbranch_execz L_sr14
    buffer_load_dwordx4 v[112:115], v61, s[16:19], s30 offen offset:2048 sc1
    s_branch L_sc13
L_sr14:
    s_bitset0_b32 s33, 4
L_sc13:
    s_bitcmp1_b32 s33, 5
    s_cbranch_scc0 L_sc15
    v_xor_b32 v116, s64, v116
    v_xor_b32 v117, s65, v117
    v_xor_b32 v118, s66, v118
    v_xor_b32 v119, s67, v119
    v_or3_b32 v32, v116, v117, v118
    v_bitop3_b32 v32, v32, v119, s69 bitop3:0x54
    v_cmp_ne_u32 vcc, 0, v32
    s_cbranch_vccz L_sr16
    s_cbranch_execz L_sr16
    buffer_load_dwordx4 v[116:119], v61, s[16:19], s30 offen offset:2560 sc1
    s_branch L_sc15
L_sr16:
    s_bitset0_b32 s33, 5
L_sc15:
    s_bitcmp1_b32 s33, 6
    s_cbranch_scc0 L_sc17
    v_xor_b32 v120, s64, v120
    v_xor_b32 v121, s65, v121
    v_xor_b32 v122, s66, v122
    v_xor_b32 v123, s67, v123
    v_or3_b32 v32, v120, v121, v122
    v_bitop3_b32 v32, v32, v123, s69 bitop3:0x54
    v_cmp_ne_u32 vcc, 0, v32
    s_cbranch_vccz L_sr18
    s_cbranch_execz L_sr18
    buffer_load_dwordx4 v[120:123], v61, s[16:19], s30 offen offset:3072 sc1
    s_branch L_sc17
L_sr18:
    s_bitset0_b32 s33, 6
L_sc17:
    s_bitcmp1_b32 s33, 7
    s_cbranch_scc0 L_sc19
    v_xor_b32 v124, s64, v124
    v_xor_b32 v125, s65, v125
    v_xor_b32 v126, s66, v126
    v_xor_b32 v127, s67, v127
    v_or3_b32 v32, v124, v125, v126
    v_bitop3_b32 v32, v32, v127, s69 bitop3:0x54
    v_cmp_ne_u32 vcc, 0, v32
    s_cbranch_vccz L_sr20
    s_cbranch_execz L_sr20
    buffer_load_dwordx4 v[124:127], v61, s[16:19], s30 offen offset:3584 sc1
    s_branch L_sc19
L_sr20:
    s_bitset0_b32 s33, 7
L_sc19:
    s_cmp_lg_u32 s33, 0
    s_cbranch_scc1 L_sp1
L_spd2:
    v_pk_add_f32 v[96:97], v[96:97], v[100:101]
    v_pk_add_f32 v[98:99], v[98:99], v[102:103]
    v_pk_add_f32 v[104:105], v[104:105], v[108:109]
    v_pk_add_f32 v[106:107], v[106:107], v[110:111]
    v_pk_add_f32 v[112:113], v[112:113], v[116:117]
    v_pk_add_f32 v[114:115], v[114:115], v[118:119]
    v_pk_add_f32 v[120:121], v[120:121], v[124:125]
    v_pk_add_f32 v[122:123], v[122:123], v[126:127]
    v_pk_add_f32 v[96:97], v[96:97], v[104:105]
    v_pk_add_f32 v[98:99], v[98:99], v[106:107]
    v_pk_add_f32 v[112:113], v[112:113], v[120:121]
    v_pk_add_f32 v[114:115], v[114:115], v[122:123]
    v_pk_add_f32 v[96:97], v[96:97], v[112:113]
    v_pk_add_f32 v[98:99], v[98:99], v[114:115]
    s_nop 1
    v_permlane32_swap_b32 v96, v98
    v_permlane32_swap_b32 v97, v99
    v_cvt_pk_bf16_f32 v36, v96, v97
    v_cvt_pk_bf16_f32 v37, v98, v99
    v_lshlrev_b32 v96, 16, v36
    v_and_b32 v97, s70, v36
    v_lshlrev_b32 v98, 16, v37
    v_and_b32 v99, s70, v37
    v_pk_add_f32 v[98:99], v[98:99], 1.0 op_sel_hi:[1,0]
    v_cvt_pk_bf16_f32 v36, v98, v99
    v_lshlrev_b32 v98, 16, v36
    v_and_b32 v99, s70, v36
    v_pk_mul_f32 v[98:99], v[98:99], v[16:17]
    v_cvt_pk_bf16_f32 v36, v98, v99
    v_lshlrev_b32 v98, 16, v36
    v_and_b32 v99, s70, v36
    v_pk_add_f32 v[98:99], v[98:99], v[96:97]
    v_cvt_pk_bf16_f32 v55, v98, v99
    ds_write_b32 v58, v55
    ds_read_b128 v[24:27], v59
    ds_read_b128 v[28:31], v59 offset:16
    s_waitcnt lgkmcnt(0)
    v_mfma_f32_16x16x32_bf16 v[32:35], v[24:27], v[128:131], 0
    v_mfma_f32_16x16x32_bf16 v[36:39], v[24:27], v[132:135], 0
    v_mfma_f32_16x16x32_bf16 v[40:43], v[24:27], v[136:139], 0
    v_mfma_f32_16x16x32_bf16 v[44:47], v[24:27], v[140:143], 0
    v_mfma_f32_16x16x32_bf16 v[32:35], v[28:31], v[144:147], v[32:35]
    v_mfma_f32_16x16x32_bf16 v[36:39], v[28:31], v[148:151], v[36:39]
    v_mfma_f32_16x16x32_bf16 v[40:43], v[28:31], v[152:155], v[40:43]
    v_mfma_f32_16x16x32_bf16 v[44:47], v[28:31], v[156:159], v[44:47]
    s_nop 5
    ds_write2_b32 v20, v32, v36 offset0:0 offset1:1
    s_nop 0
    ds_write2_b32 v20, v40, v44 offset0:2 offset1:3
    s_waitcnt lgkmcnt(0)
    s_cbranch_execz L_nb21
    s_barrier
L_nb21:
    s_cbranch_execz L_exit
    s_mov_b32 s12, s56
    s_mov_b32 s13, s57
    s_mov_b32 s14, 0x300000
    s_mov_b32 s15, 0x00020000
    s_mul_i32 s30, s7, 6144
    s_and_b32 s28, s5, 3
    s_lshl_b32 s29, s28, 7
    s_add_u32 s30, s30, s29
    s_lshl_b32 s29, s4, 9
    s_add_u32 s30, s30, s29
    s_add_u32 s30, s30, 2048
    v_lshrrev_b32 v12, 3, v2
    v_lshl_add_u32 v14, v1, 3, v12
    v_mul_u32_u24 v14, 6144, v14
    v_and_b32 v15, 7, v2
    v_lshlrev_b32 v15, 4, v15
    v_add_u32 v14, v14, v15
    s_setprio 1
    s_barrier
    s_add_u32 s29, s30, 0
    buffer_load_dwordx4 v[96:99], v14, s[12:15], s29 offen nt
    s_add_u32 s29, s30, 12288
    buffer_load_dwordx4 v[100:103], v14, s[12:15], s29 offen nt
    s_add_u32 s29, s30, 24576
    buffer_load_dwordx4 v[104:107], v14, s[12:15], s29 offen nt
    s_add_u32 s29, s30, 36864
    buffer_load_dwordx4 v[108:111], v14, s[12:15], s29 offen nt
    s_setprio 0
    s_add_u32 s29, s91, 0
    buffer_load_dwordx4 v[64:67], v21, s[8:11], s29 offen nt
    s_add_u32 s29, s91, 16384
    buffer_load_dwordx4 v[68:71], v21, s[8:11], s29 offen nt
    s_add_u32 s29, s91, 2048
    buffer_load_dwordx4 v[72:75], v21, s[8:11], s29 offen nt
    s_add_u32 s29, s91, 18432
    buffer_load_dwordx4 v[76:79], v21, s[8:11], s29 offen nt
    s_lshr_b32 s28, s3, 1
    v_lshlrev_b32 v61, 4, v2
    v_lshl_add_u32 v61, v1, 11, v61
    s_mul_i32 s30, s4, 49152
    s_lshl_b32 s29, s3, 8
    s_add_u32 s30, s30, s29
    s_add_u32 s30, s30, 262144
    v_and_b32 v13, 3, v2
    v_min_u32 v14, 2, v13
    v_bfe_u32 v15, v2, 2, 1
    v_mul_u32_u24 v52, 12, v15
    v_lshl_add_u32 v52, v14, 2, v52
    v_add_u32 v52, v52, v1
    v_lshlrev_b32 v52, 7, v52
    s_mul_i32 s31, s4, 3072
    s_lshl_b32 s29, s28, 4
    s_add_u32 s31, s31, s29
    s_add_u32 s31, s31, 196608
    s_mov_b32 s74, 0x77777777
    s_mov_b32 s75, 0x77777777
    s_mov_b32 s82, 0
    s_lshl_b32 s28, s3, 9
    s_add_u32 s29, s28, 1024
    v_lshlrev_b32 v54, 6, v15
    v_lshl_add_u32 v54, v1, 4, v54
    v_add_u32 v54, s29, v54
    ds_read_b128 v[24:27], v54 offset:256
    s_add_u32 s76, s30, 8192
    s_add_u32 s77, s30, 16384
    s_add_u32 s78, s30, 24576
    s_add_u32 s79, s30, 32768
    s_add_u32 s80, s30, 40960
    s_waitcnt vmcnt(7)
    v_mov_b32 v36, v96
    v_mov_b32 v37, v97
    v_mov_b32_dpp v96, v98 row_ror:8 row_mask:0xf bank_mask:0xc
    v_mov_b32_dpp v97, v99 row_ror:8 row_mask:0xf bank_mask:0xc
    v_mov_b32_dpp v98, v36 row_ror:8 row_mask:0xf bank_mask:0x3
    v_mov_b32_dpp v99, v37 row_ror:8 row_mask:0xf bank_mask:0x3
    v_perm_b32 v112, v98, v96, s88
    v_perm_b32 v116, v98, v96, s89
    v_perm_b32 v120, v99, v97, s88
    v_perm_b32 v124, v99, v97, s89
    s_waitcnt vmcnt(6)
    v_mov_b32 v36, v100
    v_mov_b32 v37, v101
    v_mov_b32_dpp v100, v102 row_ror:8 row_mask:0xf bank_mask:0xc
    v_mov_b32_dpp v101, v103 row_ror:8 row_mask:0xf bank_mask:0xc
    v_mov_b32_dpp v102, v36 row_ror:8 row_mask:0xf bank_mask:0x3
    v_mov_b32_dpp v103, v37 row_ror:8 row_mask:0xf bank_mask:0x3
    v_perm_b32 v113, v102, v100, s88
    v_perm_b32 v117, v102, v100, s89
    v_perm_b32 v121, v103, v101, s88
    v_perm_b32 v125, v103, v101, s89
    s_waitcnt vmcnt(5)
    v_mov_b32 v36, v104
    v_mov_b32 v37, v105
    v_mov_b32_dpp v104, v106 row_ror:8 row_mask:0xf bank_mask:0xc
    v_mov_b32_dpp v105, v107 row_ror:8 row_mask:0xf bank_mask:0xc
    v_mov_b32_dpp v106, v36 row_ror:8 row_mask:0xf bank_mask:0x3
    v_mov_b32_dpp v107, v37 row_ror:8 row_mask:0xf bank_mask:0x3
    v_perm_b32 v114, v106, v104, s88
    v_perm_b32 v118, v106, v104, s89
    v_perm_b32 v122, v107, v105, s88
    v_perm_b32 v126, v107, v105, s89
    s_waitcnt vmcnt(4)
    v_mov_b32 v36, v108
    v_mov_b32 v37, v109
    v_mov_b32_dpp v108, v110 row_ror:8 row_mask:0xf bank_mask:0xc
    v_mov_b32_dpp v109, v111 row_ror:8 row_mask:0xf bank_mask:0xc
    v_mov_b32_dpp v110, v36 row_ror:8 row_mask:0xf bank_mask:0x3
    v_mov_b32_dpp v111, v37 row_ror:8 row_mask:0xf bank_mask:0x3
    v_perm_b32 v115, v110, v108, s88
    v_perm_b32 v119, v110, v108, s89
    v_perm_b32 v123, v111, v109, s88
    v_perm_b32 v127, v111, v109, s89
    s_waitcnt lgkmcnt(0)
    v_mfma_f32_16x16x32_bf16 v[32:35], v[24:27], v[112:115], 0
    v_mfma_f32_16x16x32_bf16 v[36:39], v[24:27], v[116:119], 0
    v_mfma_f32_16x16x32_bf16 v[40:43], v[24:27], v[120:123], 0
    v_mfma_f32_16x16x32_bf16 v[44:47], v[24:27], v[124:127], 0
    s_nop 5
    ds_write2_b32 v62, v32, v36 offset0:0 offset1:1
    s_nop 0
    ds_write2_b32 v62, v40, v44 offset0:2 offset1:3
    s_waitcnt lgkmcnt(0)
    s_barrier
    s_barrier
    s_add_u32 s29, s91, 4096
    buffer_load_dwordx4 v[80:83], v21, s[8:11], s29 offen nt
    s_add_u32 s29, s91, 20480
    buffer_load_dwordx4 v[84:87], v21, s[8:11], s29 offen nt
    s_add_u32 s29, s91, 6144
    buffer_load_dwordx4 v[88:91], v21, s[8:11], s29 offen nt
    s_add_u32 s29, s91, 22528
    buffer_load_dwordx4 v[92:95], v21, s[8:11], s29 offen nt
    s_waitcnt vmcnt(7)
    v_mov_b32 v36, v64
    v_mov_b32 v37, v65
    v_mov_b32_dpp v64, v66 row_ror:8 row_mask:0xf bank_mask:0xc
    v_mov_b32_dpp v65, v67 row_ror:8 row_mask:0xf bank_mask:0xc
    v_mov_b32_dpp v66, v36 row_ror:8 row_mask:0xf bank_mask:0x3
    v_mov_b32_dpp v67, v37 row_ror:8 row_mask:0xf bank_mask:0x3
    v_perm_b32 v128, v66, v64, s88
    v_perm_b32 v132, v66, v64, s89
    v_perm_b32 v136, v67, v65, s88
    v_perm_b32 v140, v67, v65, s89
    s_waitcnt vmcnt(6)
    v_mov_b32 v36, v68
    v_mov_b32 v37, v69
    v_mov_b32_dpp v68, v70 row_ror:8 row_mask:0xf bank_mask:0xc
    v_mov_b32_dpp v69, v71 row_ror:8 row_mask:0xf bank_mask:0xc
    v_mov_b32_dpp v70, v36 row_ror:8 row_mask:0xf bank_mask:0x3
    v_mov_b32_dpp v71, v37 row_ror:8 row_mask:0xf bank_mask:0x3
    v_perm_b32 v129, v70, v68, s88
    v_perm_b32 v133, v70, v68, s89
    v_perm_b32 v137, v71, v69, s88
    v_perm_b32 v141, v71, v69, s89
    s_waitcnt vmcnt(5)
    v_mov_b32 v36, v72
    v_mov_b32 v37, v73
    v_mov_b32_dpp v72, v74 row_ror:8 row_mask:0xf bank_mask:0xc
    v_mov_b32_dpp v73, v75 row_ror:8 row_mask:0xf bank_mask:0xc
    v_mov_b32_dpp v74, v36 row_ror:8 row_mask:0xf bank_mask:0x3
    v_mov_b32_dpp v75, v37 row_ror:8 row_mask:0xf bank_mask:0x3
    v_perm_b32 v130, v74, v72, s88
    v_perm_b32 v134, v74, v72, s89
    v_perm_b32 v138, v75, v73, s88
    v_perm_b32 v142, v75, v73, s89
    s_waitcnt vmcnt(4)
    v_mov_b32 v36, v76
    v_mov_b32 v37, v77
    v_mov_b32_dpp v76, v78 row_ror:8 row_mask:0xf bank_mask:0xc
    v_mov_b32_dpp v77, v79 row_ror:8 row_mask:0xf bank_mask:0xc
    v_mov_b32_dpp v78, v36 row_ror:8 row_mask:0xf bank_mask:0x3
    v_mov_b32_dpp v79, v37 row_ror:8 row_mask:0xf bank_mask:0x3
    v_perm_b32 v131, v78, v76, s88
    v_perm_b32 v135, v78, v76, s89
    v_perm_b32 v139, v79, v77, s88
    v_perm_b32 v143, v79, v77, s89
    s_waitcnt vmcnt(3)
    v_mov_b32 v36, v80
    v_mov_b32 v37, v81
    v_mov_b32_dpp v80, v82 row_ror:8 row_mask:0xf bank_mask:0xc
    v_mov_b32_dpp v81, v83 row_ror:8 row_mask:0xf bank_mask:0xc
    v_mov_b32_dpp v82, v36 row_ror:8 row_mask:0xf bank_mask:0x3
    v_mov_b32_dpp v83, v37 row_ror:8 row_mask:0xf bank_mask:0x3
    v_perm_b32 v144, v82, v80, s88
    v_perm_b32 v148, v82, v80, s89
    v_perm_b32 v152, v83, v81, s88
    v_perm_b32 v156, v83, v81, s89
    s_waitcnt vmcnt(2)
    v_mov_b32 v36, v84
    v_mov_b32 v37, v85
    v_mov_b32_dpp v84, v86 row_ror:8 row_mask:0xf bank_mask:0xc
    v_mov_b32_dpp v85, v87 row_ror:8 row_mask:0xf bank_mask:0xc
    v_mov_b32_dpp v86, v36 row_ror:8 row_mask:0xf bank_mask:0x3
    v_mov_b32_dpp v87, v37 row_ror:8 row_mask:0xf bank_mask:0x3
    v_perm_b32 v145, v86, v84, s88
    v_perm_b32 v149, v86, v84, s89
    v_perm_b32 v153, v87, v85, s88
    v_perm_b32 v157, v87, v85, s89
    s_waitcnt vmcnt(1)
    v_mov_b32 v36, v88
    v_mov_b32 v37, v89
    v_mov_b32_dpp v88, v90 row_ror:8 row_mask:0xf bank_mask:0xc
    v_mov_b32_dpp v89, v91 row_ror:8 row_mask:0xf bank_mask:0xc
    v_mov_b32_dpp v90, v36 row_ror:8 row_mask:0xf bank_mask:0x3
    v_mov_b32_dpp v91, v37 row_ror:8 row_mask:0xf bank_mask:0x3
    v_perm_b32 v146, v90, v88, s88
    v_perm_b32 v150, v90, v88, s89
    v_perm_b32 v154, v91, v89, s88
    v_perm_b32 v158, v91, v89, s89
    s_waitcnt vmcnt(0)
    v_mov_b32 v36, v92
    v_mov_b32 v37, v93
    v_mov_b32_dpp v92, v94 row_ror:8 row_mask:0xf bank_mask:0xc
    v_mov_b32_dpp v93, v95 row_ror:8 row_mask:0xf bank_mask:0xc
    v_mov_b32_dpp v94, v36 row_ror:8 row_mask:0xf bank_mask:0x3
    v_mov_b32_dpp v95, v37 row_ror:8 row_mask:0xf bank_mask:0x3
    v_perm_b32 v147, v94, v92, s88
    v_perm_b32 v151, v94, v92, s89
    v_perm_b32 v155, v95, v93, s88
    v_perm_b32 v159, v95, v93, s89
L_WO:
    v_add_u32 v23, 1048576, v52
    v_add_u32 v22, 1048576, v61
    s_mov_b32 s71, 65535
    s_mov_b32 s33, 127
    s_mov_b32 s82, 0
    s_cbranch_execz L_spx24
    s_mov_b32 s33, 64
    s_mov_b32 s82, 63
    buffer_load_dwordx4 v[48:51], v23, s[16:19], s31 offen sc1
L_sp22:
    s_sub_u32 s71, s71, 1
    s_cbranch_scc1 L_spd23
    s_and_b32 s47, s71, 14
    s_cbranch_scc1 L_spt25
    v_xor_b32 v23, 1048576, v23
    v_xor_b32 v22, 1048576, v22
L_spt25:
    s_waitcnt vmcnt(0)
L_spx24:
    s_bitcmp1_b32 s33, 0
    s_cbranch_scc0 L_sc26
    v_xor_b32 v96, s64, v96
    v_xor_b32 v97, s65, v97
    v_xor_b32 v98, s66, v98
    v_xor_b32 v99, s67, v99
    v_or3_b32 v32, v96, v97, v98
    v_bitop3_b32 v32, v32, v99, s69 bitop3:0x54
    v_cmp_ne_u32 vcc, 0, v32
    s_cbranch_vccz L_sr27
    s_cbranch_execz L_sr27
    s_bitcmp1_b32 s33, 6
    s_cbranch_scc0 L_sk28
    s_bitset1_b32 s82, 0
    s_branch L_sr27
L_sk28:
    buffer_load_dwordx4 v[96:99], v22, s[16:19], s30 offen sc1
    s_branch L_sc26
L_sr27:
    s_bitset0_b32 s33, 0
L_sc26:
    s_bitcmp1_b32 s33, 1
    s_cbranch_scc0 L_sc29
    v_xor_b32 v100, s64, v100
    v_xor_b32 v101, s65, v101
    v_xor_b32 v102, s66, v102
    v_xor_b32 v103, s67, v103
    v_or3_b32 v32, v100, v101, v102
    v_bitop3_b32 v32, v32, v103, s69 bitop3:0x54
    v_cmp_ne_u32 vcc, 0, v32
    s_cbranch_vccz L_sr30
    s_cbranch_execz L_sr30
    s_bitcmp1_b32 s33, 6
    s_cbranch_scc0 L_sk31
    s_bitset1_b32 s82, 1
    s_branch L_sr30
L_sk31:
    buffer_load_dwordx4 v[100:103], v22, s[16:19], s76 offen sc1
    s_branch L_sc29
L_sr30:
    s_bitset0_b32 s33, 1
L_sc29:
    s_bitcmp1_b32 s33, 2
    s_cbranch_scc0 L_sc32
    v_xor_b32 v104, s64, v104
    v_xor_b32 v105, s65, v105
    v_xor_b32 v106, s66, v106
    v_xor_b32 v107, s67, v107
    v_or3_b32 v32, v104, v105, v106
    v_bitop3_b32 v32, v32, v107, s69 bitop3:0x54
    v_cmp_ne_u32 vcc, 0, v32
    s_cbranch_vccz L_sr33
    s_cbranch_execz L_sr33
    s_bitcmp1_b32 s33, 6
    s_cbranch_scc0 L_sk34
    s_bitset1_b32 s82, 2
    s_branch L_sr33
L_sk34:
    buffer_load_dwordx4 v[104:107], v22, s[16:19], s77 offen sc1
    s_branch L_sc32
L_sr33:
    s_bitset0_b32 s33, 2
L_sc32:
    s_bitcmp1_b32 s33, 3
    s_cbranch_scc0 L_sc35
    v_xor_b32 v108, s64, v108
    v_xor_b32 v109, s65, v109
    v_xor_b32 v110, s66, v110
    v_xor_b32 v111, s67, v111
    v_or3_b32 v32, v108, v109, v110
    v_bitop3_b32 v32, v32, v111, s69 bitop3:0x54
    v_cmp_ne_u32 vcc, 0, v32
    s_cbranch_vccz L_sr36
    s_cbranch_execz L_sr36
    s_bitcmp1_b32 s33, 6
    s_cbranch_scc0 L_sk37
    s_bitset1_b32 s82, 3
    s_branch L_sr36
L_sk37:
    buffer_load_dwordx4 v[108:111], v22, s[16:19], s78 offen sc1
    s_branch L_sc35
L_sr36:
    s_bitset0_b32 s33, 3
L_sc35:
    s_bitcmp1_b32 s33, 4
    s_cbranch_scc0 L_sc38
    v_xor_b32 v112, s64, v112
    v_xor_b32 v113, s65, v113
    v_xor_b32 v114, s66, v114
    v_xor_b32 v115, s67, v115
    v_or3_b32 v32, v112, v113, v114
    v_bitop3_b32 v32, v32, v115, s69 bitop3:0x54
    v_cmp_ne_u32 vcc, 0, v32
    s_cbranch_vccz L_sr39
    s_cbranch_execz L_sr39
    s_bitcmp1_b32 s33, 6
    s_cbranch_scc0 L_sk40
    s_bitset1_b32 s82, 4
    s_branch L_sr39
L_sk40:
    buffer_load_dwordx4 v[112:115], v22, s[16:19], s79 offen sc1
    s_branch L_sc38
L_sr39:
    s_bitset0_b32 s33, 4
L_sc38:
    s_bitcmp1_b32 s33, 5
    s_cbranch_scc0 L_sc41
    v_xor_b32 v116, s64, v116
    v_xor_b32 v117, s65, v117
    v_xor_b32 v118, s66, v118
    v_xor_b32 v119, s67, v119
    v_or3_b32 v32, v116, v117, v118
    v_bitop3_b32 v32, v32, v119, s69 bitop3:0x54
    v_cmp_ne_u32 vcc, 0, v32
    s_cbranch_vccz L_sr42
    s_cbranch_execz L_sr42
    s_bitcmp1_b32 s33, 6
    s_cbranch_scc0 L_sk43
    s_bitset1_b32 s82, 5
    s_branch L_sr42
L_sk43:
    buffer_load_dwordx4 v[116:119], v22, s[16:19], s80 offen sc1
    s_branch L_sc41
L_sr42:
    s_bitset0_b32 s33, 5
L_sc41:
    s_bitcmp1_b32 s33, 6
    s_cbranch_scc0 L_sc44
    v_xor_b32 v48, s64, v48
    v_xor_b32 v49, s65, v49
    v_xor_b32 v50, s66, v50
    v_xor_b32 v51, s67, v51
    v_or3_b32 v32, v48, v49, v50
    v_bitop3_b32 v32, v32, v51, s69 bitop3:0x54
    v_cmp_ne_u32 vcc, 0, v32
    s_cbranch_vccz L_sr45
    s_cbranch_execz L_sr45
    buffer_load_dwordx4 v[48:51], v23, s[16:19], s31 offen sc1
    s_branch L_sc44
L_sr45:
    s_bitset0_b32 s33, 6
    s_cbranch_execz L_sz46
    s_bitcmp1_b32 s82, 0
    s_cbranch_scc0 L_sq47
    buffer_load_dwordx4 v[96:99], v22, s[16:19], s30 offen sc1
L_sq47:
    s_bitcmp1_b32 s82, 1
    s_cbranch_scc0 L_sq48
    buffer_load_dwordx4 v[100:103], v22, s[16:19], s76 offen sc1
L_sq48:
    s_bitcmp1_b32 s82, 2
    s_cbranch_scc0 L_sq49
    buffer_load_dwordx4 v[104:107], v22, s[16:19], s77 offen sc1
L_sq49:
    s_bitcmp1_b32 s82, 3
    s_cbranch_scc0 L_sq50
    buffer_load_dwordx4 v[108:111], v22, s[16:19], s78 offen sc1
L_sq50:
    s_bitcmp1_b32 s82, 4
    s_cbranch_scc0 L_sq51
    buffer_load_dwordx4 v[112:115], v22, s[16:19], s79 offen sc1
L_sq51:
    s_bitcmp1_b32 s82, 5
    s_cbranch_scc0 L_sq52
    buffer_load_dwordx4 v[116:119], v22, s[16:19], s80 offen sc1
L_sq52:
    s_or_b32 s33, s33, s82
    s_mov_b32 s82, 0
L_sz46:
    v_max_f32_dpp v36, v48, v48 quad_perm:[1,0,3,2] row_mask:0xf bank_mask:0xf
    s_nop 1
    v_max_f32_dpp v36, v36, v36 quad_perm:[2,3,0,1] row_mask:0xf bank_mask:0xf
    v_mov_b32 v33, v36
    s_nop 1
    v_permlane16_swap_b32 v36, v33
    v_max_f32 v36, v36, v33
    v_mov_b32 v33, v36
    s_nop 1
    v_permlane32_swap_b32 v36, v33
    v_max_f32 v36, v36, v33
    v_sub_f32 v36, v48, v36
    v_mul_f32 v36, 0x3fb8aa3b, v36
    v_exp_f32 v36, v36
    v_cndmask_b32 v49, 0, v49, s[74:75]
    v_mul_f32 v33, v36, v49
    s_nop 1
    v_add_f32_dpp v33, v33, v33 quad_perm:[1,0,3,2] row_mask:0xf bank_mask:0xf
    s_nop 1
    v_add_f32_dpp v33, v33, v33 quad_perm:[2,3,0,1] row_mask:0xf bank_mask:0xf
    v_mov_b32 v34, v33
    s_nop 1
    v_permlane16_swap_b32 v33, v34
    v_add_f32 v33, v33, v34
    v_mov_b32 v34, v33
    s_nop 1
    v_permlane32_swap_b32 v33, v34
    v_add_f32 v33, v33, v34
    v_rcp_f32 v33, v33
    s_nop 0
    v_mul_f32 v36, v36, v33
    s_nop 1
    v_mov_b32_dpp v24, v36 row_newbcast:0 row_mask:0xf bank_mask:0xf
    v_mov_b32_dpp v25, v36 row_newbcast:1 row_mask:0xf bank_mask:0xf
    v_mov_b32_dpp v26, v36 row_newbcast:2 row_mask:0xf bank_mask:0xf
    v_mov_b32_dpp v27, v36 row_newbcast:4 row_mask:0xf bank_mask:0xf
    v_mov_b32_dpp v28, v36 row_newbcast:5 row_mask:0xf bank_mask:0xf
    v_mov_b32_dpp v29, v36 row_newbcast:6 row_mask:0xf bank_mask:0xf
L_sc44:
    s_cmp_lg_u32 s33, 0
    s_cbranch_scc1 L_sp22
L_spd23:
L_WO2:
    v_pk_mul_f32 v[32:33], v[96:97], v[24:25] op_sel_hi:[1,0]
    v_pk_mul_f32 v[34:35], v[98:99], v[24:25] op_sel_hi:[1,0]
    v_pk_mul_f32 v[36:37], v[108:109], v[26:27] op_sel:[0,1] op_sel_hi:[1,1]
    v_pk_mul_f32 v[38:39], v[110:111], v[26:27] op_sel:[0,1] op_sel_hi:[1,1]
    v_pk_fma_f32 v[32:33], v[100:101], v[24:25], v[32:33] op_sel:[0,1,0] op_sel_hi:[1,1,1]
    v_pk_fma_f32 v[34:35], v[102:103], v[24:25], v[34:35] op_sel:[0,1,0] op_sel_hi:[1,1,1]
    v_pk_fma_f32 v[36:37], v[112:113], v[28:29], v[36:37] op_sel_hi:[1,0,1]
    v_pk_fma_f32 v[38:39], v[114:115], v[28:29], v[38:39] op_sel_hi:[1,0,1]
    v_pk_fma_f32 v[32:33], v[104:105], v[26:27], v[32:33] op_sel_hi:[1,0,1]
    v_pk_fma_f32 v[34:35], v[106:107], v[26:27], v[34:35] op_sel_hi:[1,0,1]
    v_pk_fma_f32 v[36:37], v[116:117], v[28:29], v[36:37] op_sel:[0,1,0] op_sel_hi:[1,1,1]
    v_pk_fma_f32 v[38:39], v[118:119], v[28:29], v[38:39] op_sel:[0,1,0] op_sel_hi:[1,1,1]
    s_nop 0
    v_permlane16_swap_b32 v32, v36
    v_permlane16_swap_b32 v33, v37
    v_permlane16_swap_b32 v34, v38
    v_permlane16_swap_b32 v35, v39
    v_pk_add_f32 v[32:33], v[32:33], v[36:37]
    v_pk_add_f32 v[34:35], v[34:35], v[38:39]
    s_nop 1
    v_permlane32_swap_b32 v32, v34
    v_permlane32_swap_b32 v33, v35
    v_pk_add_f32 v[32:33], v[32:33], v[34:35]
    v_cvt_pk_bf16_f32 v55, v32, v33
    ds_write_b32 v58, v55
    ds_read_b128 v[24:27], v59
    ds_read_b128 v[28:31], v59 offset:16
    s_waitcnt lgkmcnt(0)
    v_mfma_f32_16x16x32_bf16 v[32:35], v[24:27], v[128:131], 0
    v_mfma_f32_16x16x32_bf16 v[36:39], v[24:27], v[132:135], 0
    v_mfma_f32_16x16x32_bf16 v[40:43], v[24:27], v[136:139], 0
    v_mfma_f32_16x16x32_bf16 v[44:47], v[24:27], v[140:143], 0
    v_mfma_f32_16x16x32_bf16 v[32:35], v[28:31], v[144:147], v[32:35]
    v_mfma_f32_16x16x32_bf16 v[36:39], v[28:31], v[148:151], v[36:39]
    v_mfma_f32_16x16x32_bf16 v[40:43], v[28:31], v[152:155], v[40:43]
    v_mfma_f32_16x16x32_bf16 v[44:47], v[28:31], v[156:159], v[44:47]
    s_nop 5
    ds_write2_b32 v63, v32, v36 offset0:0 offset1:1
    s_nop 0
    ds_write2_b32 v63, v40, v44 offset0:2 offset1:3
    s_waitcnt lgkmcnt(0)
    s_cbranch_execz L_nb53
    s_barrier
L_nb53:
    s_cbranch_execz L_exit
    s_branch L_end
L_R:
    s_setprio 3
    s_waitcnt lgkmcnt(0)
    s_load_dword s83, s[62:63], 0
    s_mov_b32 s16, s62
    s_mov_b32 s17, s63
    s_mov_b32 s18, 0x400000
    s_mov_b32 s19, 0x00020000
    v_min_u32 v12, 47, v0
    v_lshlrev_b32 v12, 7, v12
    s_mul_i32 s28, s4, 49152
    s_mul_i32 s29, s5, 6144
    s_add_u32 s28, s28, s29
    s_add_u32 s28, s28, 1310720
    buffer_load_dword v163, v12, s[16:19], s28 offen sc1
    v_min_u32 v12, 23, v0
    v_lshlrev_b32 v12, 7, v12
    s_mul_i32 s28, s4, 3072
    s_add_u32 s28, s28, 1245184
    buffer_load_dword v163, v12, s[16:19], s28 offen sc1
    v_and_b32 v21, 31, v0
    v_lshlrev_b32 v21, 4, v21
    v_lshrrev_b32 v12, 5, v0
    v_lshl_add_u32 v21, v12, 11, v21
    v_and_b32 v52, 7, v2
    v_lshlrev_b32 v52, 5, v52
    v_lshrrev_b32 v12, 3, v2
    v_lshl_add_u32 v52, v12, 4, v52
    v_and_b32 v58, 1, v1
    v_lshl_add_u32 v62, v58, 11, v52
    v_lshl_add_u32 v63, v58, 8, v52
    s_lshl_b32 s73, s4, 12
    s_lshl_b32 s28, s5, 8
    s_add_u32 s73, s73, s28
    s_add_u32 s73, s73, 131072
    s_add_u32 s74, s73, 1048576
    s_and_b32 s75, s4, 1
    s_lshl_b32 s75, s75, 2
    s_and_b32 s28, s5, 3
    s_add_u32 s75, s75, s28
    s_lshl_b32 s75, s75, 3
    s_and_b32 s28, s5, 4
    s_add_u32 s75, s75, s28
    s_lshr_b32 s28, s4, 1
    s_add_u32 s75, s75, s28
    s_lshl_b32 s75, s75, 9
    s_add_u32 s75, s75, 786432
    s_lshl_b32 s78, s5, 12
    s_lshl_b32 s29, s4, 9
    s_add_u32 s78, s78, s29
    s_add_u32 s78, s78, 720896
    s_waitcnt lgkmcnt(0)
    s_mul_i32 s68, s83, 1664525
    s_add_u32 s68, s68, 1013904223
    s_and_b32 s64, s68, 0xff
    s_bfe_u32 s65, s68, 0x70009
    s_lshl_b32 s65, s65, 1
    s_andn2_b32 s66, 1, s68
    s_or_b32 s65, s65, s66
    s_bfe_u32 s66, s68, 0x80010
    s_lshr_b32 s67, s68, 24
    v_mov_b32 v8, s64
    v_mov_b32 v9, s65
    v_mov_b32 v10, s66
    v_mov_b32 v11, s67
    s_mov_b64 exec, 0
    s_branch L_R1
L_R0:
    s_barrier
L_R1:
    s_waitcnt lgkmcnt(0)
    s_cbranch_execz L_nb54
    s_barrier
L_nb54:
    ds_read_b128 v[32:35], v21 offset:6144
    ds_read_b128 v[36:39], v21 offset:6656
    ds_read_b128 v[40:43], v21 offset:7168
    ds_read_b128 v[44:47], v21 offset:7680
    s_waitcnt lgkmcnt(0)
    v_pk_add_f32 v[32:33], v[32:33], v[36:37]
    v_pk_add_f32 v[34:35], v[34:35], v[38:39]
    v_pk_add_f32 v[40:41], v[40:41], v[44:45]
    v_pk_add_f32 v[42:43], v[42:43], v[46:47]
    v_pk_add_f32 v[32:33], v[32:33], v[40:41]
    v_pk_add_f32 v[34:35], v[34:35], v[42:43]
    v_mov_b32 v36, v32
    v_mov_b32 v37, v33
    v_mov_b32 v38, v34
    v_mov_b32 v39, v35
    v_permlane32_swap_b32 v32, v36
    v_permlane32_swap_b32 v33, v37
    v_permlane32_swap_b32 v34, v38
    v_permlane32_swap_b32 v35, v39
    v_pk_add_f32 v[32:33], v[32:33], v[36:37]
    v_pk_add_f32 v[34:35], v[34:35], v[38:39]
    v_cvt_pk_bf16_f32 v36, v32, v33
    v_cvt_pk_bf16_f32 v37, v34, v35
    v_lshlrev_b32 v32, 16, v36
    v_and_b32 v33, s70, v36
    v_lshlrev_b32 v34, 16, v37
    v_and_b32 v35, s70, v37
    v_and_or_b32 v32, v32, s69, v8
    v_and_or_b32 v33, v33, s69, v9
    v_and_or_b32 v34, v34, s69, v10
    v_and_or_b32 v35, v35, s69, v11
    s_cbranch_execz L_rs55
    s_mov_b32 exec_hi, 0
    buffer_store_dwordx4 v[32:35], v62, s[16:19], s74 offen
    buffer_store_dwordx4 v[32:35], v62, s[16:19], s73 offen sc1
    s_mov_b32 exec_hi, -1
    s_barrier
L_rs55:
    s_waitcnt lgkmcnt(0)
    s_cbranch_execz L_nb56
    s_barrier
L_nb56:
    ds_read_b128 v[32:35], v21 offset:10240
    ds_read_b128 v[36:39], v21 offset:10752
    ds_read_b128 v[40:43], v21 offset:11264
    ds_read_b128 v[44:47], v21 offset:11776
    s_waitcnt lgkmcnt(0)
    v_pk_add_f32 v[32:33], v[32:33], v[36:37]
    v_pk_add_f32 v[34:35], v[34:35], v[38:39]
    v_pk_add_f32 v[40:41], v[40:41], v[44:45]
    v_pk_add_f32 v[42:43], v[42:43], v[46:47]
    v_pk_add_f32 v[32:33], v[32:33], v[40:41]
    v_pk_add_f32 v[34:35], v[34:35], v[42:43]
    v_mov_b32 v36, v32
    v_mov_b32 v37, v33
    v_mov_b32 v38, v34
    v_mov_b32 v39, v35
    v_permlane32_swap_b32 v32, v36
    v_permlane32_swap_b32 v33, v37
    v_permlane32_swap_b32 v34, v38
    v_permlane32_swap_b32 v35, v39
    v_pk_add_f32 v[32:33], v[32:33], v[36:37]
    v_pk_add_f32 v[34:35], v[34:35], v[38:39]
    v_add_u32 v32, 0x80, v32
    v_add_u32 v33, 0x80, v33
    v_add_u32 v34, 0x80, v34
    v_add_u32 v35, 0x80, v35
    v_and_or_b32 v32, v32, s69, v8
    v_and_or_b32 v33, v33, s69, v9
    v_and_or_b32 v34, v34, s69, v10
    v_and_or_b32 v35, v35, s69, v11
    s_cbranch_execz L_rs57
    s_mov_b32 exec_hi, 0
    buffer_store_dwordx4 v[32:35], v63, s[16:19], s75 offen sc1
    s_mov_b32 exec_hi, -1
    s_barrier
L_rs57:
    s_waitcnt lgkmcnt(0)
    s_cbranch_execz L_nb58
    s_barrier
L_nb58:
    ds_read_b128 v[32:35], v21 offset:14336
    ds_read_b128 v[36:39], v21 offset:14848
    ds_read_b128 v[40:43], v21 offset:15360
    ds_read_b128 v[44:47], v21 offset:15872
    s_waitcnt lgkmcnt(0)
    v_pk_add_f32 v[32:33], v[32:33], v[36:37]
    v_pk_add_f32 v[34:35], v[34:35], v[38:39]
    v_pk_add_f32 v[40:41], v[40:41], v[44:45]
    v_pk_add_f32 v[42:43], v[42:43], v[46:47]
    v_pk_add_f32 v[32:33], v[32:33], v[40:41]
    v_pk_add_f32 v[34:35], v[34:35], v[42:43]
    v_mov_b32 v36, v32
    v_mov_b32 v37, v33
    v_mov_b32 v38, v34
    v_mov_b32 v39, v35
    v_permlane32_swap_b32 v32, v36
    v_permlane32_swap_b32 v33, v37
    v_permlane32_swap_b32 v34, v38
    v_permlane32_swap_b32 v35, v39
    v_pk_add_f32 v[32:33], v[32:33], v[36:37]
    v_pk_add_f32 v[34:35], v[34:35], v[38:39]
    v_add_u32 v32, 0x80, v32
    v_add_u32 v33, 0x80, v33
    v_add_u32 v34, 0x80, v34
    v_add_u32 v35, 0x80, v35
    v_and_or_b32 v32, v32, s69, v8
    v_and_or_b32 v33, v33, s69, v9
    v_and_or_b32 v34, v34, s69, v10
    v_and_or_b32 v35, v35, s69, v11
    s_cbranch_execz L_rs59
    s_mov_b32 exec_hi, 0
    buffer_store_dwordx4 v[32:35], v63, s[16:19], s78 offen sc1
    s_mov_b32 exec_hi, -1
    s_branch L_end
L_rs59:
    s_mov_b64 exec, -1
    s_branch L_R0
L_Wx:
    s_cmp_eq_u32 s3, 9
    s_cbranch_scc1 L_R
    s_waitcnt lgkmcnt(0)
    s_mov_b64 exec, 0
    s_cmp_eq_u32 s3, 99
    s_cbranch_scc1 L_Q
    s_cmp_lg_u32 s3, 10
    s_cbranch_scc1 L_exit
    s_branch L_WO
L_H0:
    s_mov_b32 s16, s62
    s_mov_b32 s17, s63
    s_mov_b32 s18, 0x400000
    s_mov_b32 s19, 0x00020000
    s_waitcnt lgkmcnt(0)
    s_mul_i32 s68, s83, 1664525
    s_add_u32 s68, s68, 1013904223
    s_and_b32 s64, s68, 0xff
    s_bfe_u32 s65, s68, 0x70009
    s_lshl_b32 s65, s65, 1
    s_andn2_b32 s66, 1, s68
    s_or_b32 s65, s65, s66
    s_bfe_u32 s66, s68, 0x80010
    s_lshr_b32 s67, s68, 24
    v_mov_b32 v8, s64
    v_mov_b32 v9, s65
    v_mov_b32 v10, s66
    v_mov_b32 v11, s67
    s_mov_b32 s34, 0x07060302
    v_and_b32 v12, 3, v2
    v_lshrrev_b32 v13, 2, v2
    v_lshlrev_b32 v14, 3, v0
    v_mul_u32_u24 v25, 48, v13
    v_lshl_add_u32 v27, v1, 2, v12
    v_lshl_add_u32 v27, v13, 5, v27
    v_lshlrev_b32 v27, 4, v27
    v_lshlrev_b32 v28, 4, v13
    v_min_u32 v26, 10, v0
    v_lshlrev_b32 v26, 2, v26
    v_add_u32 v29, 30720, v3
    v_add_u32 v31, 88064, v3
    v_mov_b32 v22, 0x3fb8aa3b
    s_mul_i32 s72, s4, 24
    s_mul_i32 s73, s6, 12
    s_add_u32 s72, s72, s73
    s_add_u32 s72, s72, s7
    s_lshl_b32 s73, s72, 11
    s_add_u32 s73, s73, 262144
    s_lshl_b32 s72, s72, 7
    s_add_u32 s72, s72, 196608
    s_add_u32 s74, s72, 1048576
    s_add_u32 s75, s73, 1048576
    s_sub_u32 s28, s5, 8
    v_and_b32 v5, 3, v0
    v_lshrrev_b32 v4, 2, v0
    v_mul_u32_u24 v4, 3584, v4
    v_lshl_add_u32 v4, v5, 7, v4
    s_mul_i32 s76, s28, 114688
    s_lshl_b32 s31, s94, 9
    s_add_u32 s76, s76, s31
    s_add_u32 s77, s76, 57344
    v_lshlrev_b32 v5, 7, v0
    s_lshl_b32 s78, s94, 4
    s_add_u32 s78, s78, s28
    s_lshl_b32 s78, s78, 14
    s_add_u32 s79, s78, 8192
    s_mov_b32 s8, s48
    s_mov_b32 s9, s49
    s_mov_b32 s10, 0x1c0000
    s_mov_b32 s11, 0x00020000
    s_mov_b32 s12, s50
    s_mov_b32 s13, s51
    s_mov_b32 s14, 0x1c0000
    s_mov_b32 s15, 0x00020000
    s_mov_b32 s20, s52
    s_mov_b32 s21, s53
    s_mov_b32 s22, 0x1c0000
    s_mov_b32 s23, 0x00020000
    s_lshl_b32 s29, s35, 1
    s_sub_u32 s30, s29, 6
    v_mov_b32 v6, s30
    s_waitcnt vmcnt(24)
    ds_write_b32 v30, v6 offset:48
    s_sub_u32 s30, s29, 4
    v_mov_b32 v6, s30
    s_waitcnt vmcnt(16)
    ds_write_b32 v30, v6 offset:48
    s_sub_u32 s30, s29, 2
    v_mov_b32 v6, s30
    s_waitcnt vmcnt(8)
    ds_write_b32 v30, v6 offset:48
    s_waitcnt vmcnt(0)
    ds_write_b32 v30, v30 offset:48
L_H:
L_f1:
    ds_read_b32 v16, v26 offset:448
    ds_read_b128 v[32:35], v25 offset:0
    ds_read_b128 v[36:39], v25 offset:16
    ds_read_b128 v[40:43], v25 offset:32
    ds_read_b128 v[44:47], v25 offset:192
    ds_read_b128 v[48:51], v25 offset:208
    ds_read_b128 v[52:55], v25 offset:224
    s_waitcnt lgkmcnt(0)
    v_cmp_eq_u32 vcc, 0, v16
    s_cbranch_vccz L_f1d
    s_sleep 1
    s_branch L_f1
L_f1d:
    v_max3_f32 v16, v32, v33, v34
    v_max3_f32 v17, v35, v36, v37
    v_max3_f32 v18, v38, v39, v40
    v_max3_f32 v16, v16, v41, v42
    v_max3_f32 v16, v16, v17, v18
    v_pk_add_f32 v[32:33], v[32:33], v[16:17] op_sel_hi:[1,0] neg_lo:[0,1] neg_hi:[0,1]
    v_pk_add_f32 v[34:35], v[34:35], v[16:17] op_sel_hi:[1,0] neg_lo:[0,1] neg_hi:[0,1]
    v_pk_add_f32 v[36:37], v[36:37], v[16:17] op_sel_hi:[1,0] neg_lo:[0,1] neg_hi:[0,1]
    v_pk_add_f32 v[38:39], v[38:39], v[16:17] op_sel_hi:[1,0] neg_lo:[0,1] neg_hi:[0,1]
    v_pk_add_f32 v[40:41], v[40:41], v[16:17] op_sel_hi:[1,0] neg_lo:[0,1] neg_hi:[0,1]
    v_pk_add_f32 v[42:43], v[42:43], v[16:17] op_sel_hi:[1,0] neg_lo:[0,1] neg_hi:[0,1]
    v_pk_mul_f32 v[32:33], v[32:33], v[22:23] op_sel_hi:[1,0]
    v_pk_mul_f32 v[34:35], v[34:35], v[22:23] op_sel_hi:[1,0]
    v_pk_mul_f32 v[36:37], v[36:37], v[22:23] op_sel_hi:[1,0]
    v_pk_mul_f32 v[38:39], v[38:39], v[22:23] op_sel_hi:[1,0]
    v_pk_mul_f32 v[40:41], v[40:41], v[22:23] op_sel_hi:[1,0]
    v_pk_mul_f32 v[42:43], v[42:43], v[22:23] op_sel_hi:[1,0]
    v_exp_f32 v32, v32
    v_exp_f32 v33, v33
    v_exp_f32 v34, v34
    v_exp_f32 v35, v35
    v_exp_f32 v36, v36
    v_exp_f32 v37, v37
    v_exp_f32 v38, v38
    v_exp_f32 v39, v39
    v_exp_f32 v40, v40
    v_exp_f32 v41, v41
    v_exp_f32 v42, v42
    v_pk_mul_f32 v[18:19], v[32:33], v[44:45]
    v_pk_fma_f32 v[18:19], v[34:35], v[46:47], v[18:19]
    v_pk_fma_f32 v[18:19], v[36:37], v[48:49], v[18:19]
    v_pk_fma_f32 v[18:19], v[38:39], v[50:51], v[18:19]
    v_pk_fma_f32 v[18:19], v[40:41], v[52:53], v[18:19]
    v_add_f32 v17, v18, v19
    v_fmac_f32 v17, v42, v54
    v_mov_b32 v18, 0
    v_mov_b32 v19, 0
    v_add_u32 v16, 0x80, v16
    v_add_u32 v17, 0x80, v17
    v_add_u32 v18, 0x80, v18
    v_add_u32 v19, 0x80, v19
    v_and_or_b32 v16, v16, s69, v8
    v_and_or_b32 v17, v17, s69, v9
    v_and_or_b32 v18, v18, s69, v10
    v_and_or_b32 v19, v19, s69, v11
    s_cbranch_execz L_col
    s_mov_b64 exec, 0x1111
    buffer_store_dwordx4 v[16:19], v28, s[16:19], s74 offen
    buffer_store_dwordx4 v[16:19], v28, s[16:19], s72 offen sc1
    s_mov_b64 exec, -1
L_col:
    ds_read_b32 v162, v30 offset:40
    ds_read_b128 v[144:147], v31 offset:24576
    ds_read_b128 v[148:151], v31 offset:25600
    ds_read_b32 v161, v30 offset:36
    ds_read_b128 v[136:139], v31 offset:16384
    ds_read_b128 v[140:143], v31 offset:17408
    ds_read_b32 v160, v30 offset:32
    ds_read_b128 v[128:131], v31 offset:8192
    ds_read_b128 v[132:135], v31 offset:9216
    ds_read_b32 v159, v30 offset:28
    ds_read_b128 v[120:123], v31 offset:0
    ds_read_b128 v[124:127], v31 offset:1024
    ds_read_b32 v158, v30 offset:24
    ds_read_b128 v[112:115], v29 offset:49152
    ds_read_b128 v[116:119], v29 offset:50176
    ds_read_b32 v157, v30 offset:20
    ds_read_b128 v[104:107], v29 offset:40960
    ds_read_b128 v[108:111], v29 offset:41984
    ds_read_b32 v156, v30 offset:16
    ds_read_b128 v[96:99], v29 offset:32768
    ds_read_b128 v[100:103], v29 offset:33792
    ds_read_b32 v155, v30 offset:12
    ds_read_b128 v[88:91], v29 offset:24576
    ds_read_b128 v[92:95], v29 offset:25600
    ds_read_b32 v154, v30 offset:8
    ds_read_b128 v[80:83], v29 offset:16384
    ds_read_b128 v[84:87], v29 offset:17408
    ds_read_b32 v153, v30 offset:4
    ds_read_b128 v[72:75], v29 offset:8192
    ds_read_b128 v[76:79], v29 offset:9216
    ds_read_b32 v152, v30 offset:0
    ds_read_b128 v[64:67], v29 offset:0
    ds_read_b128 v[68:71], v29 offset:1024
    s_waitcnt lgkmcnt(0)
L_cchk10:
    v_cmp_eq_u32 vcc, 0, v162
    s_cbranch_vccz L_cadd10
    ds_read_b32 v162, v30 offset:40
    ds_read_b128 v[144:147], v31 offset:24576
    ds_read_b128 v[148:151], v31 offset:25600
    ds_read_b32 v161, v30 offset:36
    ds_read_b128 v[136:139], v31 offset:16384
    ds_read_b128 v[140:143], v31 offset:17408
    ds_read_b32 v160, v30 offset:32
    ds_read_b128 v[128:131], v31 offset:8192
    ds_read_b128 v[132:135], v31 offset:9216
    ds_read_b32 v159, v30 offset:28
    ds_read_b128 v[120:123], v31 offset:0
    ds_read_b128 v[124:127], v31 offset:1024
    s_waitcnt lgkmcnt(0)
    s_branch L_cchk10
L_cadd10:
    v_pk_mul_f32 v[56:57], v[144:145], v[42:43] op_sel_hi:[1,0]
    v_pk_mul_f32 v[58:59], v[146:147], v[42:43] op_sel_hi:[1,0]
    v_pk_mul_f32 v[60:61], v[148:149], v[42:43] op_sel_hi:[1,0]
    v_pk_mul_f32 v[62:63], v[150:151], v[42:43] op_sel_hi:[1,0]
L_cchk9:
    v_cmp_eq_u32 vcc, 0, v161
    s_cbranch_vccz L_cadd9
    ds_read_b32 v161, v30 offset:36
    ds_read_b128 v[136:139], v31 offset:16384
    ds_read_b128 v[140:143], v31 offset:17408
    ds_read_b32 v160, v30 offset:32
    ds_read_b128 v[128:131], v31 offset:8192
    ds_read_b128 v[132:135], v31 offset:9216
    ds_read_b32 v159, v30 offset:28
    ds_read_b128 v[120:123], v31 offset:0
    ds_read_b128 v[124:127], v31 offset:1024
    ds_read_b32 v158, v30 offset:24
    ds_read_b128 v[112:115], v29 offset:49152
    ds_read_b128 v[116:119], v29 offset:50176
    s_waitcnt lgkmcnt(0)
    s_branch L_cchk9
L_cadd9:
    v_pk_fma_f32 v[56:57], v[136:137], v[40:41], v[56:57] op_sel:[0,1,0] op_sel_hi:[1,1,1]
    v_pk_fma_f32 v[58:59], v[138:139], v[40:41], v[58:59] op_sel:[0,1,0] op_sel_hi:[1,1,1]
    v_pk_fma_f32 v[60:61], v[140:141], v[40:41], v[60:61] op_sel:[0,1,0] op_sel_hi:[1,1,1]
    v_pk_fma_f32 v[62:63], v[142:143], v[40:41], v[62:63] op_sel:[0,1,0] op_sel_hi:[1,1,1]
L_cchk8:
    v_cmp_eq_u32 vcc, 0, v160
    s_cbranch_vccz L_cadd8
    ds_read_b32 v160, v30 offset:32
    ds_read_b128 v[128:131], v31 offset:8192
    ds_read_b128 v[132:135], v31 offset:9216
    ds_read_b32 v159, v30 offset:28
    ds_read_b128 v[120:123], v31 offset:0
    ds_read_b128 v[124:127], v31 offset:1024
    ds_read_b32 v158, v30 offset:24
    ds_read_b128 v[112:115], v29 offset:49152
    ds_read_b128 v[116:119], v29 offset:50176
    ds_read_b32 v157, v30 offset:20
    ds_read_b128 v[104:107], v29 offset:40960
    ds_read_b128 v[108:111], v29 offset:41984
    s_waitcnt lgkmcnt(0)
    s_branch L_cchk8
L_cadd8:
    v_pk_fma_f32 v[56:57], v[128:129], v[40:41], v[56:57] op_sel_hi:[1,0,1]
    v_pk_fma_f32 v[58:59], v[130:131], v[40:41], v[58:59] op_sel_hi:[1,0,1]
    v_pk_fma_f32 v[60:61], v[132:133], v[40:41], v[60:61] op_sel_hi:[1,0,1]
    v_pk_fma_f32 v[62:63], v[134:135], v[40:41], v[62:63] op_sel_hi:[1,0,1]
L_cchk7:
    v_cmp_eq_u32 vcc, 0, v159
    s_cbranch_vccz L_cadd7
    ds_read_b32 v159, v30 offset:28
    ds_read_b128 v[120:123], v31 offset:0
    ds_read_b128 v[124:127], v31 offset:1024
    ds_read_b32 v158, v30 offset:24
    ds_read_b128 v[112:115], v29 offset:49152
    ds_read_b128 v[116:119], v29 offset:50176
    ds_read_b32 v157, v30 offset:20
    ds_read_b128 v[104:107], v29 offset:40960
    ds_read_b128 v[108:111], v29 offset:41984
    ds_read_b32 v156, v30 offset:16
    ds_read_b128 v[96:99], v29 offset:32768
    ds_read_b128 v[100:103], v29 offset:33792
    s_waitcnt lgkmcnt(0)
    s_branch L_cchk7
L_cadd7:
    v_pk_fma_f32 v[56:57], v[120:121], v[38:39], v[56:57] op_sel:[0,1,0] op_sel_hi:[1,1,1]
    v_pk_fma_f32 v[58:59], v[122:123], v[38:39], v[58:59] op_sel:[0,1,0] op_sel_hi:[1,1,1]
    v_pk_fma_f32 v[60:61], v[124:125], v[38:39], v[60:61] op_sel:[0,1,0] op_sel_hi:[1,1,1]
    v_pk_fma_f32 v[62:63], v[126:127], v[38:39], v[62:63] op_sel:[0,1,0] op_sel_hi:[1,1,1]
L_cchk6:
    v_cmp_eq_u32 vcc, 0, v158
    s_cbranch_vccz L_cadd6
    ds_read_b32 v158, v30 offset:24
    ds_read_b128 v[112:115], v29 offset:49152
    ds_read_b128 v[116:119], v29 offset:50176
    ds_read_b32 v157, v30 offset:20
    ds_read_b128 v[104:107], v29 offset:40960
    ds_read_b128 v[108:111], v29 offset:41984
    ds_read_b32 v156, v30 offset:16
    ds_read_b128 v[96:99], v29 offset:32768
    ds_read_b128 v[100:103], v29 offset:33792
    ds_read_b32 v155, v30 offset:12
    ds_read_b128 v[88:91], v29 offset:24576
    ds_read_b128 v[92:95], v29 offset:25600
    s_waitcnt lgkmcnt(0)
    s_branch L_cchk6
L_cadd6:
    v_pk_fma_f32 v[56:57], v[112:113], v[38:39], v[56:57] op_sel_hi:[1,0,1]
    v_pk_fma_f32 v[58:59], v[114:115], v[38:39], v[58:59] op_sel_hi:[1,0,1]
    v_pk_fma_f32 v[60:61], v[116:117], v[38:39], v[60:61] op_sel_hi:[1,0,1]
    v_pk_fma_f32 v[62:63], v[118:119], v[38:39], v[62:63] op_sel_hi:[1,0,1]
L_cchk5:
    v_cmp_eq_u32 vcc, 0, v157
    s_cbranch_vccz L_cadd5
    ds_read_b32 v157, v30 offset:20
    ds_read_b128 v[104:107], v29 offset:40960
    ds_read_b128 v[108:111], v29 offset:41984
    ds_read_b32 v156, v30 offset:16
    ds_read_b128 v[96:99], v29 offset:32768
    ds_read_b128 v[100:103], v29 offset:33792
    ds_read_b32 v155, v30 offset:12
    ds_read_b128 v[88:91], v29 offset:24576
    ds_read_b128 v[92:95], v29 offset:25600
    ds_read_b32 v154, v30 offset:8
    ds_read_b128 v[80:83], v29 offset:16384
    ds_read_b128 v[84:87], v29 offset:17408
    s_waitcnt lgkmcnt(0)
    s_branch L_cchk5
L_cadd5:
    v_pk_fma_f32 v[56:57], v[104:105], v[36:37], v[56:57] op_sel:[0,1,0] op_sel_hi:[1,1,1]
    v_pk_fma_f32 v[58:59], v[106:107], v[36:37], v[58:59] op_sel:[0,1,0] op_sel_hi:[1,1,1]
    v_pk_fma_f32 v[60:61], v[108:109], v[36:37], v[60:61] op_sel:[0,1,0] op_sel_hi:[1,1,1]
    v_pk_fma_f32 v[62:63], v[110:111], v[36:37], v[62:63] op_sel:[0,1,0] op_sel_hi:[1,1,1]
L_cchk4:
    v_cmp_eq_u32 vcc, 0, v156
    s_cbranch_vccz L_cadd4
    ds_read_b32 v156, v30 offset:16
    ds_read_b128 v[96:99], v29 offset:32768
    ds_read_b128 v[100:103], v29 offset:33792
    ds_read_b32 v155, v30 offset:12
    ds_read_b128 v[88:91], v29 offset:24576
    ds_read_b128 v[92:95], v29 offset:25600
    ds_read_b32 v154, v30 offset:8
    ds_read_b128 v[80:83], v29 offset:16384
    ds_read_b128 v[84:87], v29 offset:17408
    ds_read_b32 v153, v30 offset:4
    ds_read_b128 v[72:75], v29 offset:8192
    ds_read_b128 v[76:79], v29 offset:9216
    s_waitcnt lgkmcnt(0)
    s_branch L_cchk4
L_cadd4:
    v_pk_fma_f32 v[56:57], v[96:97], v[36:37], v[56:57] op_sel_hi:[1,0,1]
    v_pk_fma_f32 v[58:59], v[98:99], v[36:37], v[58:59] op_sel_hi:[1,0,1]
    v_pk_fma_f32 v[60:61], v[100:101], v[36:37], v[60:61] op_sel_hi:[1,0,1]
    v_pk_fma_f32 v[62:63], v[102:103], v[36:37], v[62:63] op_sel_hi:[1,0,1]
L_cchk3:
    v_cmp_eq_u32 vcc, 0, v155
    s_cbranch_vccz L_cadd3
    ds_read_b32 v155, v30 offset:12
    ds_read_b128 v[88:91], v29 offset:24576
    ds_read_b128 v[92:95], v29 offset:25600
    ds_read_b32 v154, v30 offset:8
    ds_read_b128 v[80:83], v29 offset:16384
    ds_read_b128 v[84:87], v29 offset:17408
    ds_read_b32 v153, v30 offset:4
    ds_read_b128 v[72:75], v29 offset:8192
    ds_read_b128 v[76:79], v29 offset:9216
    ds_read_b32 v152, v30 offset:0
    ds_read_b128 v[64:67], v29 offset:0
    ds_read_b128 v[68:71], v29 offset:1024
    s_waitcnt lgkmcnt(0)
    s_branch L_cchk3
L_cadd3:
    v_pk_fma_f32 v[56:57], v[88:89], v[34:35], v[56:57] op_sel:[0,1,0] op_sel_hi:[1,1,1]
    v_pk_fma_f32 v[58:59], v[90:91], v[34:35], v[58:59] op_sel:[0,1,0] op_sel_hi:[1,1,1]
    v_pk_fma_f32 v[60:61], v[92:93], v[34:35], v[60:61] op_sel:[0,1,0] op_sel_hi:[1,1,1]
    v_pk_fma_f32 v[62:63], v[94:95], v[34:35], v[62:63] op_sel:[0,1,0] op_sel_hi:[1,1,1]
L_cchk2:
    v_cmp_eq_u32 vcc, 0, v154
    s_cbranch_vccz L_cadd2
    ds_read_b32 v154, v30 offset:8
    ds_read_b128 v[80:83], v29 offset:16384
    ds_read_b128 v[84:87], v29 offset:17408
    ds_read_b32 v153, v30 offset:4
    ds_read_b128 v[72:75], v29 offset:8192
    ds_read_b128 v[76:79], v29 offset:9216
    ds_read_b32 v152, v30 offset:0
    ds_read_b128 v[64:67], v29 offset:0
    ds_read_b128 v[68:71], v29 offset:1024
    s_waitcnt lgkmcnt(0)
    s_branch L_cchk2
L_cadd2:
    v_pk_fma_f32 v[56:57], v[80:81], v[34:35], v[56:57] op_sel_hi:[1,0,1]
    v_pk_fma_f32 v[58:59], v[82:83], v[34:35], v[58:59] op_sel_hi:[1,0,1]
    v_pk_fma_f32 v[60:61], v[84:85], v[34:35], v[60:61] op_sel_hi:[1,0,1]
    v_pk_fma_f32 v[62:63], v[86:87], v[34:35], v[62:63] op_sel_hi:[1,0,1]
L_cchk1:
    v_cmp_eq_u32 vcc, 0, v153
    s_cbranch_vccz L_cadd1
    ds_read_b32 v153, v30 offset:4
    ds_read_b128 v[72:75], v29 offset:8192
    ds_read_b128 v[76:79], v29 offset:9216
    ds_read_b32 v152, v30 offset:0
    ds_read_b128 v[64:67], v29 offset:0
    ds_read_b128 v[68:71], v29 offset:1024
    s_waitcnt lgkmcnt(0)
    s_branch L_cchk1
L_cadd1:
    v_pk_fma_f32 v[56:57], v[72:73], v[32:33], v[56:57] op_sel:[0,1,0] op_sel_hi:[1,1,1]
    v_pk_fma_f32 v[58:59], v[74:75], v[32:33], v[58:59] op_sel:[0,1,0] op_sel_hi:[1,1,1]
    v_pk_fma_f32 v[60:61], v[76:77], v[32:33], v[60:61] op_sel:[0,1,0] op_sel_hi:[1,1,1]
    v_pk_fma_f32 v[62:63], v[78:79], v[32:33], v[62:63] op_sel:[0,1,0] op_sel_hi:[1,1,1]
L_cchk0:
    v_cmp_eq_u32 vcc, 0, v152
    s_cbranch_vccz L_cadd0
    ds_read_b32 v152, v30 offset:0
    ds_read_b128 v[64:67], v29 offset:0
    ds_read_b128 v[68:71], v29 offset:1024
    s_waitcnt lgkmcnt(0)
    s_branch L_cchk0
L_cadd0:
    v_pk_fma_f32 v[56:57], v[64:65], v[32:33], v[56:57] op_sel_hi:[1,0,1]
    v_pk_fma_f32 v[58:59], v[66:67], v[32:33], v[58:59] op_sel_hi:[1,0,1]
    v_pk_fma_f32 v[60:61], v[68:69], v[32:33], v[60:61] op_sel_hi:[1,0,1]
    v_pk_fma_f32 v[62:63], v[70:71], v[32:33], v[62:63] op_sel_hi:[1,0,1]
    v_add_u32 v56, 0x80, v56
    v_add_u32 v57, 0x80, v57
    v_add_u32 v58, 0x80, v58
    v_add_u32 v59, 0x80, v59
    v_and_or_b32 v56, v56, s69, v8
    v_and_or_b32 v57, v57, s69, v9
    v_and_or_b32 v58, v58, s69, v10
    v_and_or_b32 v59, v59, s69, v11
    v_add_u32 v60, 0x80, v60
    v_add_u32 v61, 0x80, v61
    v_add_u32 v62, 0x80, v62
    v_add_u32 v63, 0x80, v63
    v_and_or_b32 v60, v60, s69, v8
    v_and_or_b32 v61, v61, s69, v9
    v_and_or_b32 v62, v62, s69, v10
    v_and_or_b32 v63, v63, s69, v11
    s_cbranch_execz L_dryH
    buffer_store_dwordx4 v[56:59], v27, s[16:19], s75 offen
    buffer_store_dwordx4 v[60:63], v27, s[16:19], s75 offen offset:256
    buffer_store_dwordx4 v[56:59], v27, s[16:19], s73 offen sc1
    buffer_store_dwordx4 v[60:63], v27, s[16:19], s73 offen offset:256 sc1
    ds_write_b32 v30, v30 offset:56
    s_waitcnt lgkmcnt(0)
    s_cmp_eq_u32 s35, 10
    s_cbranch_scc1 L_end
    s_cmp_eq_u32 s94, 7
    s_cbranch_scc1 L_end
    buffer_load_dword v163, v4, s[8:11], s76 offen
    buffer_load_dword v163, v4, s[12:15], s76 offen
    buffer_load_dword v163, v4, s[8:11], s77 offen
    buffer_load_dword v163, v4, s[12:15], s77 offen
    buffer_load_dword v163, v5, s[20:23], s78 offen
    buffer_load_dword v163, v5, s[20:23], s79 offen
    s_branch L_end
L_dryH:
    s_mov_b64 exec, -1
    s_branch L_att
L_T:
    s_sub_u32 s3, s3, 2
    v_lshrrev_b32 v13, 2, v2
    v_mul_u32_u24 v25, 48, v13
    s_lshl_b32 s29, s3, 2
    v_add_u32 v26, s29, v25
    v_mov_b32 v30, s29
    v_mov_b32 v16, 0
    v_mov_b32 v17, 0
    v_mov_b32 v18, 0
    v_mov_b32 v19, 0
    v_mov_b32 v28, 384
    s_sub_u32 s82, s35, s3
    s_sub_u32 s82, s82, 1
    s_lshl_b32 s29, s82, 2
    v_mov_b32 v24, s29
    ds_write_b32 v30, v16 offset:384
    ds_write_b32 v30, v16 offset:448
    ds_write_b32 v30, v16 offset:768
    ds_write_b32 v30, v16 offset:784
    ds_write_b128 v28, v[16:19] offset:48
    s_lshl_b32 s31, s3, 13
    s_add_u32 s28, s28, s31
    s_add_u32 s30, s28, 4096
    s_add_u32 s31, s31, 30720
    s_mov_b32 s74, 0x11111111
    s_mov_b32 s75, 0x11111111
    s_mov_b32 s76, 0x22222222
    s_mov_b32 s77, 0x22222222
    s_mov_b32 s78, 0x44444444
    s_mov_b32 s79, 0x44444444
    s_mov_b32 s80, 0x88888888
    s_mov_b32 s81, 0x88888888
    s_mov_b32 s33, 0x05040100
    s_mov_b32 s34, 0x07060302
    v_and_b32 v12, 3, v2
    v_lshl_add_u32 v14, v12, 2, v13
    v_lshlrev_b32 v14, 8, v14
    v_xor_b32 v15, v1, v2
    v_lshl_add_u32 v14, v15, 4, v14
    v_add_u32 v4, s31, v14
    v_xor_b32 v5, 64, v4
    v_xor_b32 v6, 0x80, v4
    v_xor_b32 v7, 0xc0, v4
    v_mul_u32_u24 v15, 320, v13
    v_lshl_add_u32 v15, v1, 4, v15
    v_add_u32 v29, 32, v15
    v_and_b32 v29, 0xf0, v29
    v_add_u32 v29, 1280, v29
    s_mov_b32 s92, 0xaaaaaaaa
    s_mov_b32 s93, 0xaaaaaaaa
    v_cndmask_b32 v25, v29, v15, s[92:93]
    v_cndmask_b32 v15, v15, v29, s[92:93]
    v_lshlrev_b32 v29, 3, v0
    ds_write_b64 v29, v[16:17] offset:2304
    v_cndmask_b32 v12, 0, -1, s[74:75]
    v_cndmask_b32 v13, 0, -1, s[76:77]
    v_cndmask_b32 v21, 0, -1, s[78:79]
    v_cndmask_b32 v23, 0, -1, s[80:81]
    v_add_u32 v29, s31, v3
    v_mov_b32 v31, 1
    v_mov_b32 v20, 0x3db504f3
    v_mov_b32 v22, 0x3fb8aa3b
    s_waitcnt lgkmcnt(0)
    s_barrier
    s_mov_b32 s12, s40
    s_mov_b32 s13, s41
    s_mov_b32 s14, 0x8000000
    s_mov_b32 s15, 0x00020000
    s_load_dword s83, s[62:63], 0
    s_mov_b32 s16, s62
    s_mov_b32 s17, s63
    s_mov_b32 s18, 0x400000
    s_mov_b32 s19, 0x00020000
    s_lshl_b32 s32, s4, 1
    s_add_u32 s32, s32, s6
    s_lshl_b32 s32, s32, 11
    s_add_u32 s32, s32, 131072
    v_lshrrev_b32 v14, 5, v0
    v_lshlrev_b32 v14, 6, v14
    v_lshl_add_u32 v14, v0, 3, v14
    s_waitcnt lgkmcnt(0)
    s_mul_i32 s68, s83, 1664525
    s_add_u32 s68, s68, 1013904223
    s_and_b32 s64, s68, 0xff
    s_bfe_u32 s65, s68, 0x70009
    s_lshl_b32 s65, s65, 1
    s_andn2_b32 s66, 1, s68
    s_or_b32 s65, s65, s66
    s_bfe_u32 s66, s68, 0x80010
    s_lshr_b32 s67, s68, 24
    v_mov_b32 v8, s64
    v_mov_b32 v9, s65
    v_mov_b32 v10, s66
    v_mov_b32 v11, s67
    s_cmp_lg_u32 s3, 4
    s_cbranch_scc1 L_nd4
    s_mov_b64 exec, 0
    s_branch L_H
L_nd4:
    s_cmp_lg_u32 s3, 5
    s_cbranch_scc1 L_att
    s_mov_b64 exec, 0
L_att:
    s_lshl_b32 s73, s3, 1
    s_add_u32 s73, s73, 2
    s_add_u32 s90, s35, 0
    s_mov_b32 s72, 0
    s_cbranch_execz L_k
    s_setprio 3
L_ev:
    ds_read_b32 v16, v24 offset:768
    ds_read_b64 v[18:19], v28 offset:48
    s_waitcnt lgkmcnt(0)
    s_bitcmp1_b32 s72, 0
    s_cbranch_scc1 L_ev1
    v_cmp_ne_u32 vcc, 0, v16
    s_cbranch_vccnz L_v
L_ev1:
    s_bitcmp1_b32 s72, 3
    s_cbranch_scc0 L_ev1b
    s_getreg_b32 s29, hwreg(HW_REG_IB_STS, 0, 4)
    s_cmp_gt_u32 s29, 6
    s_cbranch_scc1 L_ev1b
    ds_write_b32 v24, v31 offset:788
    s_bitset0_b32 s72, 3
L_ev1b:
    s_bitcmp1_b32 s72, 1
    s_cbranch_scc1 L_ev2
    v_cmp_le_u32 vcc, s73, v18
    s_cbranch_vccnz L_k
    s_branch L_ev3
L_ev2:
    s_bitcmp1_b32 s72, 2
    s_cbranch_scc1 L_ev3
    v_cmp_ne_u32 vcc, 0, v19
    s_cbranch_vccnz L_sc
L_ev3:
    s_sleep 1
    s_branch L_ev
L_v:
    buffer_load_dwordx4 v[32:35], v3, s[12:15], s28 offen offset:0 nt
    buffer_load_dwordx4 v[36:39], v3, s[12:15], s28 offen offset:1024 nt
    buffer_load_dwordx4 v[40:43], v3, s[12:15], s28 offen offset:2048 nt
    buffer_load_dwordx4 v[44:47], v3, s[12:15], s28 offen offset:3072 nt
    buffer_load_dwordx4 v[48:51], v3, s[12:15], s30 offen offset:0 nt
    buffer_load_dwordx4 v[52:55], v3, s[12:15], s30 offen offset:1024 nt
    buffer_load_dwordx4 v[56:59], v3, s[12:15], s30 offen offset:2048 nt
    buffer_load_dwordx4 v[60:63], v3, s[12:15], s30 offen offset:3072 nt
    s_add_u32 s29, s82, 5
    s_cmp_ge_u32 s29, s90
    s_cbranch_scc1 L_v2
    s_bitset1_b32 s72, 3
L_v2:
    s_bitcmp1_b32 s72, 2
    s_cbranch_scc1 L_pv
    s_bitset1_b32 s72, 0
    s_setprio 0
    s_branch L_ev
L_k:
    ds_read_b128 v[96:99], v4 offset:0
    ds_read_b128 v[112:115], v4 offset:4096
    ds_read_b128 v[100:103], v5 offset:0
    ds_read_b128 v[116:119], v5 offset:4096
    ds_read_b128 v[104:107], v6 offset:0
    ds_read_b128 v[120:123], v6 offset:4096
    ds_read_b128 v[108:111], v7 offset:0
    ds_read_b128 v[124:127], v7 offset:4096
    s_bitset1_b32 s72, 1
    s_cbranch_execz L_sc
    s_cmp_lg_u32 s3, 0
    s_cbranch_scc1 L_ev
    s_mov_b32 s71, 65535
    v_mov_b32 v27, v3
    s_and_b32 s47, s71, 15
    s_cselect_b32 s47, 1048576, 0
    v_add_u32 v27, s47, v3
    buffer_load_dwordx4 v[64:67], v27, s[16:19], s32 offen sc1
    buffer_load_dwordx4 v[68:71], v27, s[16:19], s32 offen offset:1024 sc1
    s_sleep 8
    s_and_b32 s47, s71, 15
    s_cselect_b32 s47, 1048576, 0
    v_add_u32 v27, s47, v3
    buffer_load_dwordx4 v[72:75], v27, s[16:19], s32 offen sc1
    buffer_load_dwordx4 v[76:79], v27, s[16:19], s32 offen offset:1024 sc1
    s_sleep 8
L_qp:
    s_and_b32 s47, s71, 15
    s_cselect_b32 s47, 1048576, 0
    v_add_u32 v27, s47, v3
    buffer_load_dwordx4 v[80:83], v27, s[16:19], s32 offen sc1
    buffer_load_dwordx4 v[84:87], v27, s[16:19], s32 offen offset:1024 sc1
    s_waitcnt vmcnt(4)
    v_xor_b32 v64, s64, v64
    v_xor_b32 v65, s65, v65
    v_xor_b32 v66, s66, v66
    v_xor_b32 v67, s67, v67
    v_xor_b32 v68, s64, v68
    v_xor_b32 v69, s65, v69
    v_xor_b32 v70, s66, v70
    v_xor_b32 v71, s67, v71
    v_or3_b32 v16, v64, v65, v66
    v_or3_b32 v16, v16, v67, v68
    v_or3_b32 v16, v16, v69, v70
    v_bitop3_b32 v16, v16, v71, s69 bitop3:0x54
    v_cmp_ne_u32 vcc, 0, v16
    v_perm_b32 v144, v65, v64, s34
    v_perm_b32 v145, v67, v66, s34
    v_perm_b32 v146, v69, v68, s34
    v_perm_b32 v147, v71, v70, s34
    s_cbranch_vccz L_qd
    s_sub_u32 s71, s71, 1
    s_cbranch_scc1 L_qd
    s_and_b32 s47, s71, 15
    s_cselect_b32 s47, 1048576, 0
    v_add_u32 v27, s47, v3
    buffer_load_dwordx4 v[64:67], v27, s[16:19], s32 offen sc1
    buffer_load_dwordx4 v[68:71], v27, s[16:19], s32 offen offset:1024 sc1
    s_waitcnt vmcnt(4)
    v_xor_b32 v72, s64, v72
    v_xor_b32 v73, s65, v73
    v_xor_b32 v74, s66, v74
    v_xor_b32 v75, s67, v75
    v_xor_b32 v76, s64, v76
    v_xor_b32 v77, s65, v77
    v_xor_b32 v78, s66, v78
    v_xor_b32 v79, s67, v79
    v_or3_b32 v16, v72, v73, v74
    v_or3_b32 v16, v16, v75, v76
    v_or3_b32 v16, v16, v77, v78
    v_bitop3_b32 v16, v16, v79, s69 bitop3:0x54
    v_cmp_ne_u32 vcc, 0, v16
    v_perm_b32 v144, v73, v72, s34
    v_perm_b32 v145, v75, v74, s34
    v_perm_b32 v146, v77, v76, s34
    v_perm_b32 v147, v79, v78, s34
    s_cbranch_vccz L_qd
    s_sub_u32 s71, s71, 1
    s_cbranch_scc1 L_qd
    s_and_b32 s47, s71, 15
    s_cselect_b32 s47, 1048576, 0
    v_add_u32 v27, s47, v3
    buffer_load_dwordx4 v[72:75], v27, s[16:19], s32 offen sc1
    buffer_load_dwordx4 v[76:79], v27, s[16:19], s32 offen offset:1024 sc1
    s_waitcnt vmcnt(4)
    v_xor_b32 v80, s64, v80
    v_xor_b32 v81, s65, v81
    v_xor_b32 v82, s66, v82
    v_xor_b32 v83, s67, v83
    v_xor_b32 v84, s64, v84
    v_xor_b32 v85, s65, v85
    v_xor_b32 v86, s66, v86
    v_xor_b32 v87, s67, v87
    v_or3_b32 v16, v80, v81, v82
    v_or3_b32 v16, v16, v83, v84
    v_or3_b32 v16, v16, v85, v86
    v_bitop3_b32 v16, v16, v87, s69 bitop3:0x54
    v_cmp_ne_u32 vcc, 0, v16
    v_perm_b32 v144, v81, v80, s34
    v_perm_b32 v145, v83, v82, s34
    v_perm_b32 v146, v85, v84, s34
    v_perm_b32 v147, v87, v86, s34
    s_cbranch_vccz L_qd
    s_sub_u32 s71, s71, 1
    s_cbranch_scc1 L_qd
    s_branch L_qp
L_qd:
    ds_write_b64 v14, v[144:145] offset:1024
    ds_write_b64 v14, v[146:147] offset:1664
    ds_write_b32 v28, v28 offset:52
    s_bitcmp1_b32 s72, 0
    s_cbranch_scc0 L_sc
    s_waitcnt vmcnt(0)
L_sc:
    s_setprio 2
    ds_read_b128 v[128:131], v15 offset:1024
    ds_read_b128 v[144:147], v25 offset:1024
    ds_read_b128 v[132:135], v15 offset:1088
    ds_read_b128 v[148:151], v25 offset:1088
    ds_read_b128 v[136:139], v15 offset:1152
    ds_read_b128 v[152:155], v25 offset:1152
    ds_read_b128 v[140:143], v15 offset:1216
    ds_read_b128 v[156:159], v25 offset:1216
    s_waitcnt lgkmcnt(6)
    v_mfma_f32_16x16x32_bf16 v[160:163], v[96:99], v[128:131], 0
    v_mfma_f32_16x16x32_bf16 v[160:163], v[112:115], v[144:147], v[160:163]
    s_waitcnt lgkmcnt(4)
    v_mfma_f32_16x16x32_bf16 v[160:163], v[100:103], v[132:135], v[160:163]
    v_mfma_f32_16x16x32_bf16 v[160:163], v[116:119], v[148:151], v[160:163]
    s_waitcnt lgkmcnt(2)
    v_mfma_f32_16x16x32_bf16 v[160:163], v[104:107], v[136:139], v[160:163]
    v_mfma_f32_16x16x32_bf16 v[160:163], v[120:123], v[152:155], v[160:163]
    s_waitcnt lgkmcnt(0)
    v_mfma_f32_16x16x32_bf16 v[160:163], v[108:111], v[140:143], v[160:163]
    v_mfma_f32_16x16x32_bf16 v[160:163], v[124:127], v[156:159], v[160:163]
    s_nop 7
    v_cvt_pk_bf16_f32 v16, v160, v161
    v_cvt_pk_bf16_f32 v17, v162, v163
    v_lshlrev_b32 v160, 16, v16
    v_and_b32 v161, s70, v16
    v_lshlrev_b32 v162, 16, v17
    v_and_b32 v163, s70, v17
    v_pk_mul_f32 v[160:161], v[160:161], v[20:21] op_sel_hi:[1,0]
    v_pk_mul_f32 v[162:163], v[162:163], v[20:21] op_sel_hi:[1,0]
    v_cvt_pk_bf16_f32 v16, v160, v161
    v_cvt_pk_bf16_f32 v17, v162, v163
    v_lshlrev_b32 v160, 16, v16
    v_and_b32 v161, s70, v16
    v_lshlrev_b32 v162, 16, v17
    v_and_b32 v163, s70, v17
    v_max3_f32 v16, v160, v161, v162
    v_max_f32 v16, v16, v163
    s_nop 1
    v_max_f32_dpp v16, v16, v16 quad_perm:[1,0,3,2] row_mask:0xf bank_mask:0xf
    v_mov_b32 v17, v16
    s_nop 1
    v_permlane16_swap_b32 v16, v17
    v_max_f32 v16, v16, v17
    v_mov_b32 v17, v16
    s_nop 1
    v_permlane32_swap_b32 v16, v17
    v_max_f32 v16, v16, v17
    ds_write_b32 v26, v16 offset:0
    v_pk_add_f32 v[160:161], v[160:161], v[16:17] op_sel_hi:[1,0] neg_lo:[0,1] neg_hi:[0,1]
    v_pk_add_f32 v[162:163], v[162:163], v[16:17] op_sel_hi:[1,0] neg_lo:[0,1] neg_hi:[0,1]
    v_pk_mul_f32 v[160:161], v[160:161], v[22:23] op_sel_hi:[1,0]
    v_pk_mul_f32 v[162:163], v[162:163], v[22:23] op_sel_hi:[1,0]
    v_exp_f32 v160, v160
    v_exp_f32 v161, v161
    v_exp_f32 v162, v162
    v_exp_f32 v163, v163
    s_nop 0
    v_pk_add_f32 v[96:97], v[160:161], v[162:163]
    v_add_f32 v17, v96, v97
    v_cvt_pk_bf16_f32 v96, v160, v161
    v_cvt_pk_bf16_f32 v97, v162, v163
    v_add_f32_dpp v17, v17, v17 quad_perm:[1,0,3,2] row_mask:0xf bank_mask:0xf
    v_mov_b32 v18, v17
    s_nop 1
    v_permlane16_swap_b32 v17, v18
    v_add_f32 v17, v17, v18
    v_mov_b32 v18, v17
    s_nop 1
    v_permlane32_swap_b32 v17, v18
    v_add_f32 v17, v17, v18
    ds_write_b32 v26, v17 offset:192
    ds_write_b32 v30, v31 offset:448
    v_and_b32_dpp v128, v96, v12 quad_perm:[0,0,0,0] row_mask:0xf bank_mask:0xf
    v_and_b32_dpp v129, v97, v12 quad_perm:[0,0,0,0] row_mask:0xf bank_mask:0xf
    v_and_b32_dpp v130, v96, v12 quad_perm:[1,1,1,1] row_mask:0xf bank_mask:0xf
    v_and_b32_dpp v131, v97, v12 quad_perm:[1,1,1,1] row_mask:0xf bank_mask:0xf
    v_and_b32_dpp v132, v96, v13 quad_perm:[0,0,0,0] row_mask:0xf bank_mask:0xf
    v_and_b32_dpp v133, v97, v13 quad_perm:[0,0,0,0] row_mask:0xf bank_mask:0xf
    v_and_b32_dpp v134, v96, v13 quad_perm:[1,1,1,1] row_mask:0xf bank_mask:0xf
    v_and_b32_dpp v135, v97, v13 quad_perm:[1,1,1,1] row_mask:0xf bank_mask:0xf
    v_and_b32_dpp v136, v96, v21 quad_perm:[0,0,0,0] row_mask:0xf bank_mask:0xf
    v_and_b32_dpp v137, v97, v21 quad_perm:[0,0,0,0] row_mask:0xf bank_mask:0xf
    v_and_b32_dpp v138, v96, v21 quad_perm:[1,1,1,1] row_mask:0xf bank_mask:0xf
    v_and_b32_dpp v139, v97, v21 quad_perm:[1,1,1,1] row_mask:0xf bank_mask:0xf
    v_and_b32_dpp v140, v96, v23 quad_perm:[0,0,0,0] row_mask:0xf bank_mask:0xf
    v_and_b32_dpp v141, v97, v23 quad_perm:[0,0,0,0] row_mask:0xf bank_mask:0xf
    v_and_b32_dpp v142, v96, v23 quad_perm:[1,1,1,1] row_mask:0xf bank_mask:0xf
    v_and_b32_dpp v143, v97, v23 quad_perm:[1,1,1,1] row_mask:0xf bank_mask:0xf
    s_cbranch_execz L_pv
    s_bitset1_b32 s72, 2
    s_setprio 3
    s_bitcmp1_b32 s72, 0
    s_cbranch_scc0 L_ev
L_pv:
    s_setprio 1
    s_waitcnt vmcnt(6)
    s_bitcmp1_b32 s72, 3
    s_cbranch_scc0 L_pv1
    ds_write_b32 v24, v31 offset:788
L_pv1:
    v_perm_b32 v64, v36, v32, s33
    v_perm_b32 v68, v36, v32, s34
    v_perm_b32 v72, v37, v33, s33
    v_perm_b32 v76, v37, v33, s34
    v_perm_b32 v80, v38, v34, s33
    v_perm_b32 v84, v38, v34, s34
    v_perm_b32 v88, v39, v35, s33
    v_perm_b32 v92, v39, v35, s34
    s_waitcnt vmcnt(4)
    v_perm_b32 v65, v44, v40, s33
    v_perm_b32 v69, v44, v40, s34
    v_perm_b32 v73, v45, v41, s33
    v_perm_b32 v77, v45, v41, s34
    v_perm_b32 v81, v46, v42, s33
    v_perm_b32 v85, v46, v42, s34
    v_perm_b32 v89, v47, v43, s33
    v_perm_b32 v93, v47, v43, s34
    s_waitcnt vmcnt(2)
    v_perm_b32 v66, v52, v48, s33
    v_perm_b32 v70, v52, v48, s34
    v_perm_b32 v74, v53, v49, s33
    v_perm_b32 v78, v53, v49, s34
    v_perm_b32 v82, v54, v50, s33
    v_perm_b32 v86, v54, v50, s34
    v_perm_b32 v90, v55, v51, s33
    v_perm_b32 v94, v55, v51, s34
    s_waitcnt vmcnt(0)
    v_perm_b32 v67, v60, v56, s33
    v_perm_b32 v75, v61, v57, s33
    v_perm_b32 v83, v62, v58, s33
    v_mfma_f32_16x16x32_bf16 v[152:155], v[64:67], v[128:131], 0
    v_perm_b32 v91, v63, v59, s33
    v_mfma_f32_16x16x32_bf16 v[152:155], v[72:75], v[132:135], v[152:155]
    v_perm_b32 v71, v60, v56, s34
    v_mfma_f32_16x16x32_bf16 v[152:155], v[80:83], v[136:139], v[152:155]
    v_perm_b32 v79, v61, v57, s34
    v_mfma_f32_16x16x32_bf16 v[152:155], v[88:91], v[140:143], v[152:155]
    v_perm_b32 v87, v62, v58, s34
    v_mfma_f32_16x16x32_bf16 v[156:159], v[68:71], v[128:131], 0
    v_perm_b32 v95, v63, v59, s34
    v_mfma_f32_16x16x32_bf16 v[156:159], v[76:79], v[132:135], v[156:159]
    v_mfma_f32_16x16x32_bf16 v[156:159], v[84:87], v[136:139], v[156:159]
    v_mfma_f32_16x16x32_bf16 v[156:159], v[92:95], v[140:143], v[156:159]
    s_nop 1
    ds_write_b128 v29, v[152:155]
    s_nop 4
    ds_write_b128 v29, v[156:159] offset:1024
    ds_write_b32 v30, v31 offset:384
    s_waitcnt lgkmcnt(0)
    s_cbranch_execnz L_pf
    s_mov_b64 exec, -1
    s_branch L_att
L_pf:
    s_branch L_F0
L_F0:
    s_cmp_eq_u32 s35, 11
    s_cbranch_scc1 L_end
    s_sub_u32 s3, s3, 2
    s_cmp_ge_u32 s3, 8
    s_cbranch_scc1 L_end
    s_setprio 0
    s_sub_u32 s5, s5, 24
    s_lshl_b32 s6, s94, 3
    s_add_u32 s6, s6, s5
    s_cmp_ge_u32 s6, 56
    s_cbranch_scc1 L_end
    v_lshlrev_b32 v12, 3, v2
    v_and_b32 v14, 1, v1
    v_lshl_add_u32 v12, v14, 10, v12
    v_lshrrev_b32 v15, 5, v0
    v_lshl_add_u32 v12, v15, 2, v12
    s_lshl_b32 s32, s3, 7
    s_mov_b32 s24, s36
    s_mov_b32 s25, s37
    s_mov_b32 s26, 0x800
    s_mov_b32 s27, 0x00020000
    buffer_load_dword v55, v12, s[24:27], s32 offen
    s_mov_b32 s88, 0x05040100
    s_mov_b32 s89, 0x07060302
    s_lshl_b32 s28, s3, 9
    s_add_u32 s28, s28, 1024
    v_and_b32 v58, 31, v0
    v_lshlrev_b32 v58, 3, v58
    v_lshrrev_b32 v59, 5, v0
    v_lshl_add_u32 v58, v59, 2, v58
    v_add_u32 v56, 512, v58
    v_and_b32 v56, -8, v56
    v_add_u32 v58, s28, v58
    v_and_b32 v57, 1, v1
    v_lshlrev_b32 v57, 7, v57
    v_lshl_add_u32 v57, v59, 3, v57
    s_lshl_b32 s29, s3, 4
    s_add_u32 s29, s29, 512
    v_add_u32 v57, s29, v57
    v_bfe_u32 v59, v2, 2, 1
    v_lshlrev_b32 v59, 7, v59
    v_lshl_add_u32 v59, v1, 5, v59
    v_add_u32 v59, s28, v59
    v_and_b32 v60, 31, v0
    v_lshlrev_b32 v60, 4, v60
    v_lshrrev_b32 v21, 5, v0
    v_lshl_add_u32 v21, v21, 11, v60
    v_mov_b32 v60, v21
    s_mov_b32 s34, 0
    s_mov_b32 s35, -1
    v_lshrrev_b32 v12, 3, v2
    v_and_b32 v13, 3, v2
    v_bfe_u32 v15, v2, 2, 1
    s_lshl_b32 s28, s3, 9
    s_add_u32 s29, s28, 1024
    v_lshlrev_b32 v54, 6, v15
    v_lshl_add_u32 v54, v1, 4, v54
    v_add_u32 v54, s29, v54
    v_lshrrev_b32 v16, 5, v0
    v_and_b32 v17, 1, v1
    v_lshl_add_u32 v14, v12, 2, v13
    v_lshl_add_u32 v14, v17, 3, v14
    v_lshl_add_u32 v14, v14, 1, v16
    v_lshlrev_b32 v63, 3, v15
    v_lshl_add_u32 v63, v14, 4, v63
    v_add_u32 v63, s28, v63
    v_and_b32 v14, 6, v2
    v_lshlrev_b32 v53, 3, v14
    v_lshl_add_u32 v53, v12, 3, v53
    v_and_b32 v14, 1, v2
    v_lshl_add_u32 v53, v14, 2, v53
    v_lshl_add_u32 v53, v16, 1, v53
    v_lshl_add_u32 v53, v17, 6, v53
    v_add_u32 v53, s29, v53
    v_lshl_add_u32 v160, s3, 10, v3
    v_lshl_add_u32 v14, v17, 1, v15
    v_mul_u32_u24 v62, 7168, v14
    v_lshl_add_u32 v62, v13, 5, v62
    v_lshl_add_u32 v62, v12, 4, v62
    s_mul_i32 s73, s3, 28672
    s_lshl_b32 s29, s6, 7
    s_add_u32 s73, s73, s29
    s_add_u32 s73, s73, 851968
    s_lshl_b32 s81, s3, 12
    s_add_u32 s72, s81, 786432
    s_add_u32 s81, s81, 720896
    s_mov_b32 s71, 65535
    s_mov_b32 s33, 15
    buffer_load_dwordx4 v[144:147], v60, s[16:19], s72 offen offset:0 sc1
    buffer_load_dwordx4 v[148:151], v60, s[16:19], s72 offen offset:512 sc1
    buffer_load_dwordx4 v[152:155], v60, s[16:19], s72 offen offset:1024 sc1
    buffer_load_dwordx4 v[156:159], v60, s[16:19], s72 offen offset:1536 sc1
L_sp60:
    s_sub_u32 s71, s71, 1
    s_cbranch_scc1 L_spd61
    s_waitcnt vmcnt(0)
L_spx62:
    s_bitcmp1_b32 s33, 0
    s_cbranch_scc0 L_sc64
    v_xor_b32 v144, s64, v144
    v_xor_b32 v145, s65, v145
    v_xor_b32 v146, s66, v146
    v_xor_b32 v147, s67, v147
    v_or3_b32 v32, v144, v145, v146
    v_bitop3_b32 v32, v32, v147, s69 bitop3:0x54
    v_cmp_ne_u32 vcc, 0, v32
    s_cbranch_vccz L_sr65
    buffer_load_dwordx4 v[144:147], v60, s[16:19], s72 offen offset:0 sc1
    s_branch L_sc64
L_sr65:
    s_bitset0_b32 s33, 0
    v_permlane32_swap_b32 v144, v146
    v_permlane32_swap_b32 v145, v147
    v_pk_add_f32 v[144:145], v[144:145], v[146:147]
    v_cvt_pk_bf16_f32 v49, v144, v145
    v_lshlrev_b32 v12, 16, v49
    v_and_b32 v13, s70, v49
L_sc64:
    s_bitcmp1_b32 s33, 1
    s_cbranch_scc0 L_sc66
    v_xor_b32 v148, s64, v148
    v_xor_b32 v149, s65, v149
    v_xor_b32 v150, s66, v150
    v_xor_b32 v151, s67, v151
    v_or3_b32 v32, v148, v149, v150
    v_bitop3_b32 v32, v32, v151, s69 bitop3:0x54
    v_cmp_ne_u32 vcc, 0, v32
    s_cbranch_vccz L_sr67
    buffer_load_dwordx4 v[148:151], v60, s[16:19], s72 offen offset:512 sc1
    s_branch L_sc66
L_sr67:
    s_bitset0_b32 s33, 1
    v_permlane32_swap_b32 v148, v150
    v_permlane32_swap_b32 v149, v151
    v_pk_add_f32 v[148:149], v[148:149], v[150:151]
    v_cvt_pk_bf16_f32 v49, v148, v149
    v_lshlrev_b32 v14, 16, v49
    v_and_b32 v15, s70, v49
L_sc66:
    s_bitcmp1_b32 s33, 2
    s_cbranch_scc0 L_sc68
    v_xor_b32 v152, s64, v152
    v_xor_b32 v153, s65, v153
    v_xor_b32 v154, s66, v154
    v_xor_b32 v155, s67, v155
    v_or3_b32 v32, v152, v153, v154
    v_bitop3_b32 v32, v32, v155, s69 bitop3:0x54
    v_cmp_ne_u32 vcc, 0, v32
    s_cbranch_vccz L_sr69
    buffer_load_dwordx4 v[152:155], v60, s[16:19], s72 offen offset:1024 sc1
    s_branch L_sc68
L_sr69:
    s_bitset0_b32 s33, 2
    v_permlane32_swap_b32 v152, v154
    v_permlane32_swap_b32 v153, v155
    v_pk_add_f32 v[152:153], v[152:153], v[154:155]
    v_cvt_pk_bf16_f32 v49, v152, v153
    v_lshlrev_b32 v152, 16, v49
    v_and_b32 v153, s70, v49
    v_pk_add_f32 v[152:153], v[152:153], 1.0 op_sel_hi:[1,0]
    v_cvt_pk_bf16_f32 v49, v152, v153
    v_lshlrev_b32 v16, 16, v49
    v_and_b32 v17, s70, v49
L_sc68:
    s_bitcmp1_b32 s33, 3
    s_cbranch_scc0 L_sc70
    v_xor_b32 v156, s64, v156
    v_xor_b32 v157, s65, v157
    v_xor_b32 v158, s66, v158
    v_xor_b32 v159, s67, v159
    v_or3_b32 v32, v156, v157, v158
    v_bitop3_b32 v32, v32, v159, s69 bitop3:0x54
    v_cmp_ne_u32 vcc, 0, v32
    s_cbranch_vccz L_sr71
    buffer_load_dwordx4 v[156:159], v60, s[16:19], s72 offen offset:1536 sc1
    s_branch L_sc70
L_sr71:
    s_bitset0_b32 s33, 3
    v_permlane32_swap_b32 v156, v158
    v_permlane32_swap_b32 v157, v159
    v_pk_add_f32 v[156:157], v[156:157], v[158:159]
    v_cvt_pk_bf16_f32 v49, v156, v157
    v_lshlrev_b32 v18, 16, v49
    v_and_b32 v19, s70, v49
    ds_write_b64 v160, v[18:19] offset:22536
L_sc70:
    s_cmp_lg_u32 s33, 0
    s_cbranch_scc1 L_sp60
L_spd61:
    v_lshlrev_b32 v164, 16, v55
    v_and_b32 v165, s70, v55
    v_and_b32 v36, 4, v2
    v_cmp_eq_u32 vcc, 0, v36
    v_mov_b32 v36, s50
    v_mov_b32 v38, s48
    v_cndmask_b32 v36, v36, v38, vcc
    v_mov_b32 v37, s51
    v_mov_b32 v38, s49
    v_cndmask_b32 v37, v37, v38, vcc
    v_lshrrev_b32 v39, 3, v2
    v_lshl_add_u32 v38, v1, 4, v39
    v_mul_u32_u24 v38, 3584, v38
    v_and_b32 v35, 3, v2
    v_lshl_add_u32 v38, v35, 4, v38
    s_mul_i32 s28, s3, 229376
    s_lshl_b32 s29, s6, 6
    s_add_u32 s28, s28, s29
    v_add_u32 v38, s28, v38
    v_add_co_u32 v36, vcc, v36, v38
    s_nop 1
    v_addc_co_u32 v37, vcc, 0, v37, vcc
    s_mov_b32 s28, 7168
    s_mov_b32 s29, 0
    v_lshl_add_u32 v39, v1, 3, v39
    v_and_b32 v35, 7, v2
    v_lshlrev_b32 v35, 4, v35
    v_lshl_add_u32 v39, v39, 10, v35
    s_mov_b32 s20, s52
    s_mov_b32 s21, s53
    s_mov_b32 s22, 0x1c0000
    s_mov_b32 s23, 0x00020000
    s_lshl_b32 s30, s6, 15
    s_add_u32 s30, s30, s32
    s_add_u32 s31, s30, 4096
L_sp73:
    ds_read_b32 v32, v28 offset:56
    s_waitcnt lgkmcnt(0)
    v_cmp_eq_u32 vcc, 0, v32
    s_cbranch_vccz L_spd74
    s_sleep 1
    s_branch L_sp73
L_spd74:
    global_load_dwordx4 v[96:99], v[36:37], off
    v_lshl_add_u64 v[36:37], v[36:37], 0, s[28:29]
    global_load_dwordx4 v[100:103], v[36:37], off
    v_lshl_add_u64 v[36:37], v[36:37], 0, s[28:29]
    global_load_dwordx4 v[104:107], v[36:37], off
    v_lshl_add_u64 v[36:37], v[36:37], 0, s[28:29]
    global_load_dwordx4 v[108:111], v[36:37], off
    v_lshl_add_u64 v[36:37], v[36:37], 0, s[28:29]
    global_load_dwordx4 v[112:115], v[36:37], off
    v_lshl_add_u64 v[36:37], v[36:37], 0, s[28:29]
    global_load_dwordx4 v[116:119], v[36:37], off
    v_lshl_add_u64 v[36:37], v[36:37], 0, s[28:29]
    global_load_dwordx4 v[120:123], v[36:37], off
    v_lshl_add_u64 v[36:37], v[36:37], 0, s[28:29]
    global_load_dwordx4 v[124:127], v[36:37], off
    buffer_load_dwordx4 v[128:131], v39, s[20:23], s30 offen offset:0
    buffer_load_dwordx4 v[132:135], v39, s[20:23], s30 offen offset:2048
    buffer_load_dwordx4 v[136:139], v39, s[20:23], s31 offen offset:0
    buffer_load_dwordx4 v[140:143], v39, s[20:23], s31 offen offset:2048
    s_waitcnt vmcnt(11)
    v_mov_b32 v48, v96
    v_mov_b32 v49, v97
    v_mov_b32_dpp v96, v98 row_ror:8 row_mask:0xf bank_mask:0xc
    v_mov_b32_dpp v97, v99 row_ror:8 row_mask:0xf bank_mask:0xc
    v_mov_b32_dpp v98, v48 row_ror:8 row_mask:0xf bank_mask:0x3
    v_mov_b32_dpp v99, v49 row_ror:8 row_mask:0xf bank_mask:0x3
    v_perm_b32 v64, v98, v96, s88
    v_perm_b32 v68, v98, v96, s89
    v_perm_b32 v72, v99, v97, s88
    v_perm_b32 v76, v99, v97, s89
    s_waitcnt vmcnt(10)
    v_mov_b32 v48, v100
    v_mov_b32 v49, v101
    v_mov_b32_dpp v100, v102 row_ror:8 row_mask:0xf bank_mask:0xc
    v_mov_b32_dpp v101, v103 row_ror:8 row_mask:0xf bank_mask:0xc
    v_mov_b32_dpp v102, v48 row_ror:8 row_mask:0xf bank_mask:0x3
    v_mov_b32_dpp v103, v49 row_ror:8 row_mask:0xf bank_mask:0x3
    v_perm_b32 v65, v102, v100, s88
    v_perm_b32 v69, v102, v100, s89
    v_perm_b32 v73, v103, v101, s88
    v_perm_b32 v77, v103, v101, s89
    s_waitcnt vmcnt(9)
    v_mov_b32 v48, v104
    v_mov_b32 v49, v105
    v_mov_b32_dpp v104, v106 row_ror:8 row_mask:0xf bank_mask:0xc
    v_mov_b32_dpp v105, v107 row_ror:8 row_mask:0xf bank_mask:0xc
    v_mov_b32_dpp v106, v48 row_ror:8 row_mask:0xf bank_mask:0x3
    v_mov_b32_dpp v107, v49 row_ror:8 row_mask:0xf bank_mask:0x3
    v_perm_b32 v66, v106, v104, s88
    v_perm_b32 v70, v106, v104, s89
    v_perm_b32 v74, v107, v105, s88
    v_perm_b32 v78, v107, v105, s89
    s_waitcnt vmcnt(8)
    v_mov_b32 v48, v108
    v_mov_b32 v49, v109
    v_mov_b32_dpp v108, v110 row_ror:8 row_mask:0xf bank_mask:0xc
    v_mov_b32_dpp v109, v111 row_ror:8 row_mask:0xf bank_mask:0xc
    v_mov_b32_dpp v110, v48 row_ror:8 row_mask:0xf bank_mask:0x3
    v_mov_b32_dpp v111, v49 row_ror:8 row_mask:0xf bank_mask:0x3
    v_perm_b32 v67, v110, v108, s88
    v_perm_b32 v71, v110, v108, s89
    v_perm_b32 v75, v111, v109, s88
    v_perm_b32 v79, v111, v109, s89
    s_waitcnt vmcnt(7)
    v_mov_b32 v48, v112
    v_mov_b32 v49, v113
    v_mov_b32_dpp v112, v114 row_ror:8 row_mask:0xf bank_mask:0xc
    v_mov_b32_dpp v113, v115 row_ror:8 row_mask:0xf bank_mask:0xc
    v_mov_b32_dpp v114, v48 row_ror:8 row_mask:0xf bank_mask:0x3
    v_mov_b32_dpp v115, v49 row_ror:8 row_mask:0xf bank_mask:0x3
    v_perm_b32 v80, v114, v112, s88
    v_perm_b32 v84, v114, v112, s89
    v_perm_b32 v88, v115, v113, s88
    v_perm_b32 v92, v115, v113, s89
    s_waitcnt vmcnt(6)
    v_mov_b32 v48, v116
    v_mov_b32 v49, v117
    v_mov_b32_dpp v116, v118 row_ror:8 row_mask:0xf bank_mask:0xc
    v_mov_b32_dpp v117, v119 row_ror:8 row_mask:0xf bank_mask:0xc
    v_mov_b32_dpp v118, v48 row_ror:8 row_mask:0xf bank_mask:0x3
    v_mov_b32_dpp v119, v49 row_ror:8 row_mask:0xf bank_mask:0x3
    v_perm_b32 v81, v118, v116, s88
    v_perm_b32 v85, v118, v116, s89
    v_perm_b32 v89, v119, v117, s88
    v_perm_b32 v93, v119, v117, s89
    s_waitcnt vmcnt(5)
    v_mov_b32 v48, v120
    v_mov_b32 v49, v121
    v_mov_b32_dpp v120, v122 row_ror:8 row_mask:0xf bank_mask:0xc
    v_mov_b32_dpp v121, v123 row_ror:8 row_mask:0xf bank_mask:0xc
    v_mov_b32_dpp v122, v48 row_ror:8 row_mask:0xf bank_mask:0x3
    v_mov_b32_dpp v123, v49 row_ror:8 row_mask:0xf bank_mask:0x3
    v_perm_b32 v82, v122, v120, s88
    v_perm_b32 v86, v122, v120, s89
    v_perm_b32 v90, v123, v121, s88
    v_perm_b32 v94, v123, v121, s89
    s_waitcnt vmcnt(4)
    v_mov_b32 v48, v124
    v_mov_b32 v49, v125
    v_mov_b32_dpp v124, v126 row_ror:8 row_mask:0xf bank_mask:0xc
    v_mov_b32_dpp v125, v127 row_ror:8 row_mask:0xf bank_mask:0xc
    v_mov_b32_dpp v126, v48 row_ror:8 row_mask:0xf bank_mask:0x3
    v_mov_b32_dpp v127, v49 row_ror:8 row_mask:0xf bank_mask:0x3
    v_perm_b32 v83, v126, v124, s88
    v_perm_b32 v87, v126, v124, s89
    v_perm_b32 v91, v127, v125, s88
    v_perm_b32 v95, v127, v125, s89
    s_waitcnt vmcnt(3)
    v_mov_b32 v48, v128
    v_mov_b32 v49, v129
    v_mov_b32_dpp v128, v130 row_ror:8 row_mask:0xf bank_mask:0xc
    v_mov_b32_dpp v129, v131 row_ror:8 row_mask:0xf bank_mask:0xc
    v_mov_b32_dpp v130, v48 row_ror:8 row_mask:0xf bank_mask:0x3
    v_mov_b32_dpp v131, v49 row_ror:8 row_mask:0xf bank_mask:0x3
    v_perm_b32 v96, v130, v128, s88
    v_perm_b32 v100, v130, v128, s89
    v_perm_b32 v104, v131, v129, s88
    v_perm_b32 v108, v131, v129, s89
    s_waitcnt vmcnt(2)
    v_mov_b32 v48, v132
    v_mov_b32 v49, v133
    v_mov_b32_dpp v132, v134 row_ror:8 row_mask:0xf bank_mask:0xc
    v_mov_b32_dpp v133, v135 row_ror:8 row_mask:0xf bank_mask:0xc
    v_mov_b32_dpp v134, v48 row_ror:8 row_mask:0xf bank_mask:0x3
    v_mov_b32_dpp v135, v49 row_ror:8 row_mask:0xf bank_mask:0x3
    v_perm_b32 v97, v134, v132, s88
    v_perm_b32 v101, v134, v132, s89
    v_perm_b32 v105, v135, v133, s88
    v_perm_b32 v109, v135, v133, s89
    s_waitcnt vmcnt(1)
    v_mov_b32 v48, v136
    v_mov_b32 v49, v137
    v_mov_b32_dpp v136, v138 row_ror:8 row_mask:0xf bank_mask:0xc
    v_mov_b32_dpp v137, v139 row_ror:8 row_mask:0xf bank_mask:0xc
    v_mov_b32_dpp v138, v48 row_ror:8 row_mask:0xf bank_mask:0x3
    v_mov_b32_dpp v139, v49 row_ror:8 row_mask:0xf bank_mask:0x3
    v_perm_b32 v98, v138, v136, s88
    v_perm_b32 v102, v138, v136, s89
    v_perm_b32 v106, v139, v137, s88
    v_perm_b32 v110, v139, v137, s89
    s_waitcnt vmcnt(0)
    v_mov_b32 v48, v140
    v_mov_b32 v49, v141
    v_mov_b32_dpp v140, v142 row_ror:8 row_mask:0xf bank_mask:0xc
    v_mov_b32_dpp v141, v143 row_ror:8 row_mask:0xf bank_mask:0xc
    v_mov_b32_dpp v142, v48 row_ror:8 row_mask:0xf bank_mask:0x3
    v_mov_b32_dpp v143, v49 row_ror:8 row_mask:0xf bank_mask:0x3
    v_perm_b32 v99, v142, v140, s88
    v_perm_b32 v103, v142, v140, s89
    v_perm_b32 v107, v143, v141, s88
    v_perm_b32 v111, v143, v141, s89
    s_barrier
L_F:
    s_mov_b32 s71, 65535
    s_mov_b32 s33, 15
    s_cbranch_execz L_spx77
    buffer_load_dwordx4 v[32:35], v3, s[16:19], s81 offen offset:0 sc1
    buffer_load_dwordx4 v[36:39], v3, s[16:19], s81 offen offset:1024 sc1
    buffer_load_dwordx4 v[40:43], v3, s[16:19], s81 offen offset:2048 sc1
    buffer_load_dwordx4 v[44:47], v3, s[16:19], s81 offen offset:3072 sc1
L_sp75:
    s_sub_u32 s71, s71, 1
    s_cbranch_scc1 L_spd76
    s_waitcnt vmcnt(0)
L_spx77:
    s_bitcmp1_b32 s33, 0
    s_cbranch_scc0 L_sc79
    v_xor_b32 v32, s64, v32
    v_xor_b32 v33, s65, v33
    v_xor_b32 v34, s66, v34
    v_xor_b32 v35, s67, v35
    v_or3_b32 v48, v32, v33, v34
    v_bitop3_b32 v48, v48, v35, s69 bitop3:0x54
    v_cmp_ne_u32 vcc, 0, v48
    s_cbranch_vccz L_sr80
    s_cbranch_execz L_sr80
    buffer_load_dwordx4 v[32:35], v3, s[16:19], s81 offen offset:0 sc1
    s_branch L_sc79
L_sr80:
    s_bitset0_b32 s33, 0
L_sc79:
    s_bitcmp1_b32 s33, 1
    s_cbranch_scc0 L_sc81
    v_xor_b32 v36, s64, v36
    v_xor_b32 v37, s65, v37
    v_xor_b32 v38, s66, v38
    v_xor_b32 v39, s67, v39
    v_or3_b32 v48, v36, v37, v38
    v_bitop3_b32 v48, v48, v39, s69 bitop3:0x54
    v_cmp_ne_u32 vcc, 0, v48
    s_cbranch_vccz L_sr82
    s_cbranch_execz L_sr82
    buffer_load_dwordx4 v[36:39], v3, s[16:19], s81 offen offset:1024 sc1
    s_branch L_sc81
L_sr82:
    s_bitset0_b32 s33, 1
L_sc81:
    s_bitcmp1_b32 s33, 2
    s_cbranch_scc0 L_sc83
    v_xor_b32 v40, s64, v40
    v_xor_b32 v41, s65, v41
    v_xor_b32 v42, s66, v42
    v_xor_b32 v43, s67, v43
    v_or3_b32 v48, v40, v41, v42
    v_bitop3_b32 v48, v48, v43, s69 bitop3:0x54
    v_cmp_ne_u32 vcc, 0, v48
    s_cbranch_vccz L_sr84
    s_cbranch_execz L_sr84
    buffer_load_dwordx4 v[40:43], v3, s[16:19], s81 offen offset:2048 sc1
    s_branch L_sc83
L_sr84:
    s_bitset0_b32 s33, 2
L_sc83:
    s_bitcmp1_b32 s33, 3
    s_cbranch_scc0 L_sc85
    v_xor_b32 v44, s64, v44
    v_xor_b32 v45, s65, v45
    v_xor_b32 v46, s66, v46
    v_xor_b32 v47, s67, v47
    v_or3_b32 v48, v44, v45, v46
    v_bitop3_b32 v48, v48, v47, s69 bitop3:0x54
    v_cmp_ne_u32 vcc, 0, v48
    s_cbranch_vccz L_sr86
    s_cbranch_execz L_sr86
    buffer_load_dwordx4 v[44:47], v3, s[16:19], s81 offen offset:3072 sc1
    s_branch L_sc85
L_sr86:
    s_bitset0_b32 s33, 3
L_sc85:
    s_cmp_lg_u32 s33, 0
    s_cbranch_scc1 L_sp75
L_spd76:
L_F2:
    v_pk_add_f32 v[32:33], v[32:33], v[36:37]
    v_pk_add_f32 v[34:35], v[34:35], v[38:39]
    v_pk_add_f32 v[40:41], v[40:41], v[44:45]
    v_pk_add_f32 v[42:43], v[42:43], v[46:47]
    v_pk_add_f32 v[32:33], v[32:33], v[40:41]
    v_pk_add_f32 v[34:35], v[34:35], v[42:43]
    s_nop 1
    v_permlane32_swap_b32 v32, v34
    v_permlane32_swap_b32 v33, v35
    v_pk_add_f32 v[32:33], v[32:33], v[34:35]
    v_cvt_pk_bf16_f32 v36, v32, v33
    v_lshlrev_b32 v32, 16, v36
    v_and_b32 v33, s70, v36
    v_pk_mul_f32 v[32:33], v[32:33], v[12:13]
    v_cvt_pk_bf16_f32 v36, v32, v33
    v_lshlrev_b32 v32, 16, v36
    v_and_b32 v33, s70, v36
    v_pk_add_f32 v[32:33], v[32:33], v[164:165]
    v_cvt_pk_bf16_f32 v36, v32, v33
    v_lshlrev_b32 v22, 16, v36
    v_and_b32 v23, s70, v36
    ds_write_b64 v160, v[22:23] offset:22528
    v_mov_b32_dpp v36, v22 row_newbcast:0 row_mask:0xf bank_mask:0xf
    v_pk_add_f32 v[38:39], v[22:23], v[36:37] op_sel_hi:[1,0] neg_lo:[0,1] neg_hi:[0,1]
    v_add_f32 v40, v38, v39
    v_mul_f32 v41, v38, v38
    v_fmac_f32 v41, v39, v39
    v_add_f32_dpp v40, v40, v40 row_ror:8 row_mask:0xf bank_mask:0xf
    s_nop 0
    v_add_f32_dpp v41, v41, v41 row_ror:8 row_mask:0xf bank_mask:0xf
    v_add_f32_dpp v40, v40, v40 row_ror:4 row_mask:0xf bank_mask:0xf
    s_nop 0
    v_add_f32_dpp v41, v41, v41 row_ror:4 row_mask:0xf bank_mask:0xf
    v_add_f32_dpp v40, v40, v40 row_ror:2 row_mask:0xf bank_mask:0xf
    s_nop 0
    v_add_f32_dpp v41, v41, v41 row_ror:2 row_mask:0xf bank_mask:0xf
    v_add_f32_dpp v40, v40, v40 row_ror:1 row_mask:0xf bank_mask:0xf
    s_nop 0
    v_add_f32_dpp v41, v41, v41 row_ror:1 row_mask:0xf bank_mask:0xf
    v_fmamk_f32 v36, v40, 0x3d000000, v36
    v_mul_f32 v40, v40, v40
    v_fmamk_f32 v37, v40, 0xbd000000, v41
    ds_write_b64 v57, v[36:37]
    s_waitcnt lgkmcnt(0)
    s_cbranch_execz L_nb87
    s_barrier
L_nb87:
    ds_read_b64 v[36:37], v56
    s_waitcnt lgkmcnt(0)
    v_mov_b32_dpp v38, v36 row_newbcast:0 row_mask:0xf bank_mask:0xf
    v_sub_f32 v40, v36, v38
    v_mul_f32 v39, v40, v40
    v_fmamk_f32 v41, v39, 0x42000000, v37
    v_add_f32_dpp v40, v40, v40 row_ror:8 row_mask:0xf bank_mask:0xf
    s_nop 0
    v_add_f32_dpp v41, v41, v41 row_ror:8 row_mask:0xf bank_mask:0xf
    v_add_f32_dpp v40, v40, v40 row_ror:4 row_mask:0xf bank_mask:0xf
    s_nop 0
    v_add_f32_dpp v41, v41, v41 row_ror:4 row_mask:0xf bank_mask:0xf
    v_add_f32_dpp v40, v40, v40 row_ror:2 row_mask:0xf bank_mask:0xf
    s_nop 0
    v_add_f32_dpp v41, v41, v41 row_ror:2 row_mask:0xf bank_mask:0xf
    v_add_f32_dpp v40, v40, v40 row_ror:1 row_mask:0xf bank_mask:0xf
    s_nop 0
    v_add_f32_dpp v41, v41, v41 row_ror:1 row_mask:0xf bank_mask:0xf
    v_fmamk_f32 v36, v40, 0x3d800000, v38
    v_mul_f32 v40, v40, v40
    v_fmamk_f32 v37, v40, 0xc0000000, v41
    v_mul_f32 v37, 0x3b000000, v37
    v_max_f32 v37, 0, v37
    v_cvt_pk_bf16_f32 v38, v36, v37
    v_lshlrev_b32 v36, 16, v38
    v_and_b32 v37, s70, v38
    v_add_f32 v38, 0x3727c5ac, v37
    v_pk_add_f32 v[32:33], v[22:23], v[36:37] op_sel_hi:[1,0] neg_lo:[0,1] neg_hi:[0,1]
    v_cvt_pk_bf16_f32 v38, v38, v38
    v_cvt_pk_bf16_f32 v39, v32, v33
    v_and_b32 v38, s70, v38
    v_sqrt_f32 v38, v38
    v_lshlrev_b32 v32, 16, v39
    v_and_b32 v33, s70, v39
    v_cvt_pk_bf16_f32 v38, v38, v38
    v_and_b32 v38, s70, v38
    v_rcp_f32 v38, v38
    s_nop 0
    v_pk_mul_f32 v[32:33], v[32:33], v[38:39] op_sel_hi:[1,0]
    v_cvt_pk_bf16_f32 v39, v32, v33
    v_lshlrev_b32 v32, 16, v39
    v_and_b32 v33, s70, v39
    v_pk_mul_f32 v[32:33], v[32:33], v[16:17]
    v_cvt_pk_bf16_f32 v36, v32, v33
    v_lshlrev_b32 v32, 16, v36
    v_and_b32 v33, s70, v36
    v_pk_add_f32 v[32:33], v[32:33], v[14:15]
    v_cvt_pk_bf16_f32 v55, v32, v33
    ds_write_b32 v58, v55
    ds_read_b128 v[24:27], v59
    ds_read_b128 v[28:31], v59 offset:16
    s_waitcnt lgkmcnt(0)
    v_mfma_f32_16x16x32_bf16 v[32:35], v[24:27], v[64:67], 0
    v_mfma_f32_16x16x32_bf16 v[36:39], v[24:27], v[68:71], 0
    v_mfma_f32_16x16x32_bf16 v[40:43], v[24:27], v[72:75], 0
    v_mfma_f32_16x16x32_bf16 v[44:47], v[24:27], v[76:79], 0
    v_mfma_f32_16x16x32_bf16 v[32:35], v[28:31], v[80:83], v[32:35]
    v_mfma_f32_16x16x32_bf16 v[36:39], v[28:31], v[84:87], v[36:39]
    v_mfma_f32_16x16x32_bf16 v[40:43], v[28:31], v[88:91], v[40:43]
    v_mfma_f32_16x16x32_bf16 v[44:47], v[28:31], v[92:95], v[44:47]
    s_nop 6
    v_cndmask_b32 v48, v32, v40, s[34:35]
    v_cndmask_b32 v49, v36, v44, s[34:35]
    ds_write_b64 v63, v[48:49] offset:18432
    s_waitcnt lgkmcnt(0)
    s_cbranch_execz L_nb88
    s_barrier
L_nb88:
    ds_read_b128 v[32:35], v21 offset:18432
    ds_read_b128 v[36:39], v21 offset:18944
    ds_read_b128 v[40:43], v21 offset:19456
    ds_read_b128 v[44:47], v21 offset:19968
    s_waitcnt lgkmcnt(0)
    v_pk_add_f32 v[32:33], v[32:33], v[36:37]
    v_pk_add_f32 v[34:35], v[34:35], v[38:39]
    v_pk_add_f32 v[40:41], v[40:41], v[44:45]
    v_pk_add_f32 v[42:43], v[42:43], v[46:47]
    v_pk_add_f32 v[32:33], v[32:33], v[40:41]
    v_pk_add_f32 v[34:35], v[34:35], v[42:43]
    s_nop 0
    v_permlane32_swap_b32 v32, v33
    v_permlane32_swap_b32 v34, v35
    v_add_f32 v32, v32, v33
    v_add_f32 v33, v34, v35
    v_cvt_pk_bf16_f32 v36, v32, v33
    v_lshlrev_b32 v32, 16, v36
    v_and_b32 v33, s70, v36
    v_mul_f32 v36, 0xbfb8aa3b, v32
    v_exp_f32 v36, v36
    s_nop 0
    v_add_f32 v36, 1.0, v36
    v_rcp_f32 v36, v36
    s_nop 0
    v_mul_f32 v34, v32, v36
    v_cvt_pk_bf16_f32 v34, v34, v34
    v_and_b32 v34, s70, v34
    v_mul_f32 v34, v34, v33
    v_cvt_pk_bf16_f32 v34, v34, v34
    ds_write_b16 v53, v34
    ds_read_b128 v[24:27], v54
    s_waitcnt lgkmcnt(0)
    v_mfma_f32_16x16x32_bf16 v[32:35], v[24:27], v[96:99], 0
    v_mfma_f32_16x16x32_bf16 v[36:39], v[24:27], v[100:103], 0
    v_mfma_f32_16x16x32_bf16 v[40:43], v[24:27], v[104:107], 0
    v_mfma_f32_16x16x32_bf16 v[44:47], v[24:27], v[108:111], 0
    s_nop 4
    v_add_u32 v48, 0x80, v32
    v_add_u32 v49, 0x80, v36
    v_add_u32 v50, 0x80, v40
    v_add_u32 v51, 0x80, v44
    v_and_or_b32 v48, v48, s69, v8
    v_and_or_b32 v49, v49, s69, v9
    v_and_or_b32 v50, v50, s69, v10
    v_and_or_b32 v51, v51, s69, v11
    s_cbranch_execz L_FF
    s_mov_b32 exec_hi, 0
    buffer_store_dwordx4 v[48:51], v62, s[16:19], s73 offen sc1
    s_mov_b32 exec_hi, -1
    s_cmp_ge_u32 s6, 32
    s_cbranch_scc1 L_end
    s_cmp_eq_u32 s3, 7
    s_cbranch_scc1 L_end
    s_mul_i32 s76, s6, 7168
    s_lshl_b32 s28, s3, 10
    s_add_u32 s76, s76, s28
    s_add_u32 s76, s76, 851968
    s_lshl_b32 s28, s3, 8
    v_lshlrev_b32 v36, 2, v0
    v_add_u32 v36, s28, v36
    s_waitcnt vmcnt(0)
L_FF:
    s_mov_b32 s71, 65535
    s_cbranch_execz L_pdec91
L_poll89:
    s_cbranch_execz L_pdone90
    buffer_load_dwordx4 v[44:47], v3, s[16:19], s76 offen sc1
    s_sub_u32 s71, s71, 1
    s_cbranch_scc1 L_pdone90
    s_waitcnt vmcnt(0)
L_pdec91:
    v_xor_b32 v44, s64, v44
    v_xor_b32 v45, s65, v45
    v_xor_b32 v46, s66, v46
    v_xor_b32 v47, s67, v47
    v_or3_b32 v32, v44, v45, v46
    v_bitop3_b32 v32, v32, v47, s69 bitop3:0x54
    v_cmp_ne_u32 vcc, 0, v32
    s_cbranch_vccnz L_poll89
L_pdone90:
    v_permlane32_swap_b32 v44, v46
    v_permlane32_swap_b32 v45, v47
    v_pk_add_f32 v[44:45], v[44:45], v[46:47]
    s_nop 1
    v_permlane16_swap_b32 v44, v45
    v_add_f32 v44, v44, v45
    ds_write_b32 v36, v44 offset:6144
    s_waitcnt lgkmcnt(0)
    s_cbranch_execz L_nb92
    s_barrier
L_nb92:
    s_cbranch_execz L_X3
    s_branch L_end
L_X2:
    s_sub_u32 s5, s5, 24
    s_lshl_b32 s6, s94, 3
    s_add_u32 s6, s6, s5
    s_cmp_ge_u32 s6, 56
    s_cbranch_scc1 L_end
    v_and_b32 v58, 1, v1
    s_mul_i32 s76, s6, 7168
    s_add_u32 s76, s76, 851968
    s_add_u32 s77, s76, 4096
    s_and_b32 s28, s6, 3
    s_lshl_b32 s28, s28, 3
    v_and_b32 v56, 0x27, v0
    v_add_u32 v56, s28, v56
    s_lshr_b32 s29, s6, 2
    s_lshl_b32 s32, s29, 7
    s_lshl_b32 s29, s29, 10
    v_lshlrev_b32 v59, 4, v56
    v_lshl_add_u32 v59, v58, 2, v59
    v_add_u32 v59, s29, v59
    v_and_b32 v57, 15, v56
    v_lshlrev_b32 v57, 3, v57
    v_bfe_u32 v12, v56, 4, 1
    v_lshl_add_u32 v57, v12, 10, v57
    v_lshrrev_b32 v12, 5, v56
    v_lshl_add_u32 v57, v12, 2, v57
    v_lshl_add_u32 v57, v58, 1, v57
    s_mov_b32 s24, s58
    s_mov_b32 s25, s59
    s_mov_b32 s26, 0x800
    s_mov_b32 s27, 0x00020000
    s_mov_b64 exec, 0
    s_branch L_F
L_X3:
    s_cbranch_execz L_X4
    s_cmp_ge_u32 s6, 32
    s_cbranch_scc1 L_end
    s_barrier
    s_barrier
    s_barrier
L_X4:
    ds_read_b32 v40, v59 offset:22528
    ds_read_b32 v42, v59 offset:22536
    s_waitcnt lgkmcnt(0)
    v_lshlrev_b32 v36, 2, v0
    s_waitcnt lgkmcnt(0)
    s_cbranch_execz L_nb93
    s_barrier
L_nb93:
    ds_read2st64_b32 v[44:45], v36 offset0:24 offset1:25
    ds_read2st64_b32 v[46:47], v36 offset0:26 offset1:27
    ds_read2st64_b32 v[48:49], v36 offset0:28 offset1:29
    ds_read_b32 v50, v36 offset:7680
    s_waitcnt lgkmcnt(0)
    v_pk_add_f32 v[44:45], v[44:45], v[46:47]
    v_pk_add_f32 v[44:45], v[44:45], v[48:49]
    v_add_f32 v44, v44, v45
    v_add_f32 v44, v44, v50
    s_nop 1
    v_add_f32_dpp v44, v44, v44 row_ror:8 row_mask:0xf bank_mask:0xf
    v_cvt_pk_bf16_f32 v44, v44, v44
    v_and_b32 v44, s70, v44
    v_mul_f32 v44, v44, v42
    v_cvt_pk_bf16_f32 v44, v44, v44
    v_and_b32 v44, s70, v44
    v_add_f32 v44, v44, v40
    v_cvt_pk_bf16_f32 v44, v44, v44
    s_cbranch_execz L_dry3
    s_mov_b32 exec_lo, 0x00ff00ff
    s_mov_b32 exec_hi, 0x00ff00ff
    buffer_store_short v44, v57, s[24:27], s32 offen
    s_mov_b64 exec, -1
    s_cmp_lg_u32 s6, 0
    s_cbranch_scc1 L_end
    v_mov_b32 v36, s68
    v_mov_b32 v37, 0
    s_mov_b64 exec, 1
    buffer_store_dword v36, v37, s[16:19], 0 offen
    s_mov_b64 exec, -1
    s_branch L_end
L_dry3:
    s_mov_b64 exec, -1
    s_branch L_X3
L_end:
L_exit:
    s_endpgm
.section .rodata,"a"
.p2align 6
.amdhsa_kernel adaLN_cond__sliding_block_cached__swiglu_ffn__decode_kernel
  .amdhsa_next_free_vgpr 168
  .amdhsa_next_free_sgpr 102
  .amdhsa_accum_offset 168
  .amdhsa_group_segment_fixed_size 0
  .amdhsa_kernarg_size 112
  .amdhsa_user_sgpr_count 2
  .amdhsa_user_sgpr_kernarg_segment_ptr 1
  .amdhsa_system_sgpr_workgroup_id_x 1
  .amdhsa_float_denorm_mode_32 3
.end_amdhsa_kernel
```
